```python
import torch

def _softmax(x, axis=-1):
    return torch.softmax(x, dim=axis)

def _gelu(x):
    return torch.nn.functional.gelu(x, approximate='tanh')

def _silu(x):
    return torch.nn.functional.silu(x)

def _sigmoid(x):
    return torch.sigmoid(x)

def _layernorm(x, axis=-1, eps=1e-05):
    m = x.mean(dim=axis, keepdim=True)
    v = x.var(dim=axis, keepdim=True, unbiased=False)
    return (x - m) / torch.sqrt(v + eps)

def _scatter_add(tgt, idx, src, axis=0):
    return tgt.clone().index_add_(axis, idx, src)

def _segment_sum(src, seg, n):
    out = torch.zeros((n,) + src.shape[1:], dtype=src.dtype)
    return out.index_add_(0, seg, src)

def _pad(x, pw):
    flat = tuple((v for pair in reversed(pw) for v in pair))
    return torch.nn.functional.pad(x, flat)
kernel_name = 'adaLN_cond__sliding_block_cached__glu_gated_geglu__decode'

def setup_inputs():

    _w = lambda a: (lambda t: t.to(torch.bfloat16) if t.is_floating_point() else t)(torch.as_tensor(a))

    def _A_setup():
        B, Sq, D = (4, 1, 576)
        Hq, Hkv, Sk, Dh = (32, 16, 4096, 128)
        assert Hq % Hkv == 0, (Hq, Hkv)
        return {'x': _w((lambda *s: torch.randn(*s, dtype=torch.bfloat16) * 0.05)(B, Sq, D)), 'k_cache': _w((lambda *s: torch.randn(*s, dtype=torch.bfloat16) * 0.8)(B, Hkv, Sk, Dh)), 'v_cache': _w((lambda *s: torch.randn(*s, dtype=torch.bfloat16) * 3.2)(B, Hkv, Sk, Dh)), 'wq': _w((lambda *s: torch.randn(*s, dtype=torch.bfloat16) * 0.8)(D, Hq * Dh) * D ** (-0.5)), 'wo': _w((lambda *s: torch.randn(*s, dtype=torch.bfloat16) * 3.2)(Hq * Dh, D) * (Hq * Dh) ** (-0.5))}
    _A_in = _A_setup()

    def _B_setup():
        B, S, Dm, Df = (4, 1, 576, 4608)
        return {'x': _w((lambda *s: torch.randn(*s, dtype=torch.bfloat16) * 0.05)(B, S, Dm)), 'w_gate': _w((lambda *s: torch.randn(*s, dtype=torch.bfloat16) * 3.2)(Dm, Df) * Dm ** (-0.5)), 'w_up': _w((lambda *s: torch.randn(*s, dtype=torch.bfloat16) * 3.2)(Dm, Df) * Dm ** (-0.5)), 'w_down': _w((lambda *s: torch.randn(*s, dtype=torch.bfloat16) * 3.2)(Df, Dm) * Df ** (-0.5))}
    _B_in = _B_setup()
    return {'A_x': _A_in['x'], 'A_k_cache': _A_in['k_cache'], 'A_v_cache': _A_in['v_cache'], 'A_wq': _A_in['wq'], 'A_wo': _A_in['wo'], 'B_x': _B_in['x'], 'B_w_gate': _B_in['w_gate'], 'B_w_up': _B_in['w_up'], 'B_w_down': _B_in['w_down'], 'c': _w((lambda *s: torch.randn(*s, dtype=torch.bfloat16) * 0.4)(4, 576) * 8.0), 'w_mod': _w((lambda *s: torch.randn(*s, dtype=torch.bfloat16) * 0.4)(576, 6 * 576) * 576 ** (-0.5) * 8.0)}

def reference(A_x, A_k_cache, A_v_cache, A_wq, A_wo, B_x, B_w_gate, B_w_up, B_w_down, c, w_mod):

    def _A_ref(x, k_cache, v_cache, wq, wo):
        B, Sq, D = x.shape
        Hq, Dh = (32, 128)
        Hkv, Sk = (k_cache.shape[1], k_cache.shape[2])
        W = min(4096, max(256, Sk // 4))
        rep = Hq // Hkv
        q = (lambda x, *d: x.permute(*d))((x @ wq).reshape(B, Sq, Hq, Dh), 0, 2, 1, 3)
        k = (lambda x, n, axis: torch.repeat_interleave(x, n, dim=axis))(k_cache[:, :, Sk - W:, :], rep, axis=1)
        v = (lambda x, n, axis: torch.repeat_interleave(x, n, dim=axis))(v_cache[:, :, Sk - W:, :], rep, axis=1)
        scores = torch.einsum('bhqd,bhkd->bhqk', q, k) * Dh ** (-0.5)
        p = _softmax(scores, axis=-1)
        o = torch.einsum('bhqk,bhkd->bhqd', p, v)
        return (lambda x, *d: x.permute(*d))(o, 0, 2, 1, 3).reshape(B, Sq, Hq * Dh) @ wo

    def _B_ref(x, w_gate, w_up, w_down):
        g = torch.einsum('bsd,df->bsf', x, w_gate)
        u = torch.einsum('bsd,df->bsf', x, w_up)
        h = _gelu(g) * u
        return torch.einsum('bsf,fd->bsd', h, w_down)
    x = A_x
    mod = (_silu(c) @ w_mod).reshape(c.shape[0], 6, 1, -1)
    sa, ca, ga, sb, cb, gb = (mod[:, 0].clone(), mod[:, 1].clone(), mod[:, 2].clone(), mod[:, 3].clone(), mod[:, 4].clone(), mod[:, 5].clone())
    h = _layernorm(x, axis=-1) * (1 + ca) + sa
    x = x + ga * _A_ref(h, A_k_cache, A_v_cache, A_wq, A_wo)
    h = _layernorm(x, axis=-1) * (1 + cb) + sb
    x = x + gb * _B_ref(h, B_w_gate, B_w_up, B_w_down)
    return x
```

```asm
; @launch grid=(256,1,1) block=(576,1,1) lds=163840
.amdgcn_target "amdgcn-amd-amdhsa--gfx950"
.text
.globl adaLN_cond__sliding_block_cached__glu_gated_geglu__decode_kernel
.p2align 12
.type adaLN_cond__sliding_block_cached__glu_gated_geglu__decode_kernel,@function
adaLN_cond__sliding_block_cached__glu_gated_geglu__decode_kernel:
s_cmp_ge_u32 s2, 256
s_cbranch_scc1 L_end
s_load_dwordx16 s[4:19], s[0:1], 0
s_load_dwordx8 s[20:27], s[0:1], 64
s_load_dwordx4 s[28:31], s[0:1], 96
v_readfirstlane_b32 s3, v0
v_and_b32 v0, 63, v0
s_and_b32 s32, s2, 7
s_lshr_b32 s33, s2, 3
s_lshr_b32 s3, s3, 6
s_and_b32 s50, s33, 30
s_cmp_lg_u32 s50, 14
s_cbranch_scc1 L_nowarm
s_cmp_lt_u32 s3, 6
s_cbranch_scc1 L_nowarm
s_getpc_b64 s[50:51]
L_pc:
s_sub_u32 s52, s3, 6
s_lshl_b32 s52, s52, 13
v_lshl_add_u32 v7, v0, 7, s52
v_min_u32 v7, L_end-L_pc, v7
global_load_dword v165, v7, s[50:51]
L_nowarm:
v_and_b32 v1, 15, v0
v_lshrrev_b32 v2, 4, v0
v_mov_b32 v3, 147456
v_mov_b32 v4, 1
s_mov_b32 s41, 400000
s_bfe_u32 s81, s33, 0x10003
s_lshl_b32 s50, s32, 1
s_add_u32 s81, s81, s50
s_bfe_u32 s80, s33, 0x20001
s_and_b32 s82, s33, 1
s_mov_b32 s83, 0
s_cmp_lg_u32 s3, 0
s_cbranch_scc1 L_notloader
s_setprio 3
s_mov_b32 s55, 0x20000
s_mov_b32 s59, 0x20000
s_mov_b32 s48, 0
s_cmp_ge_u32 s33, 16
s_cbranch_scc1 LD_s1
s_cmp_ge_u32 s33, 14
s_cbranch_scc1 LD_s3
s_cmp_lt_u32 s33, 6
s_cselect_b32 s50, 6, 8
s_cselect_b32 s51, 0, 6
s_cselect_b32 s61, 54, 64
s_mul_i32 s44, s32, s50
s_add_u32 s44, s44, s33
s_sub_u32 s44, s44, s51
s_lshl_b32 s61, s61, 7
s_lshl_b32 s44, s44, 7
s_mov_b32 s45, s44
s_lshl_b32 s62, s61, 5
s_mov_b32 m0, 73728
s_mov_b32 s63, -1
s_mov_b32 s64, 7
v_lshrrev_b32 v6, 3, v0
v_and_b32 v7, 2, v6
v_and_b32 v8, 7, v0
v_xor_b32 v7, v7, v8
v_lshlrev_b32 v7, 4, v7
v_mul_lo_u32 v6, v6, s61
s_lshl_b32 s50, s61, 3
s_sub_u32 s50, s50, 1024
v_add_u32 v10, v6, v7
v_xor_b32 v7, 64, v7
v_add3_u32 v11, v6, v7, s50
s_lshl_b32 s50, s50, 1
v_add_u32 v12, s50, v10
v_add_u32 v13, s50, v11
s_mul_i32 s54, s61, 576
s_mov_b32 s58, s54
s_cmp_lt_u32 s33, 6
s_waitcnt lgkmcnt(0)
s_cselect_b32 s52, s24, s10
s_cselect_b32 s53, s25, s11
s_mov_b32 s56, s52
s_mov_b32 s57, s53
s_branch LD_s2
LD_s1:
s_lshl_b32 s44, s80, 24
s_lshl_b32 s50, s81, 20
s_add_u32 s44, s44, s50
s_lshl_b32 s50, s82, 17
s_add_u32 s44, s44, s50
s_add_u32 s44, s44, 786432
s_mul_i32 s60, s2, 5
s_and_b32 s60, s60, 31
s_lshl_b32 s60, s60, 12
s_mov_b32 s45, s60
s_mov_b32 m0, 0
s_movk_i32 s62, 4096
s_mov_b32 s63, 0x1ffff
s_mov_b32 s64, 7
v_add_u32 v6, 0, v2
v_xor_b32 v6, v6, v1
v_lshl_add_u32 v6, v6, 4, s44
v_lshl_add_u32 v10, v2, 8, v6
v_add_u32 v6, 4, v2
v_xor_b32 v6, v6, v1
v_lshl_add_u32 v6, v6, 4, s44
v_lshl_add_u32 v11, v2, 8, v6
v_add_u32 v6, 8, v2
v_xor_b32 v6, v6, v1
v_lshl_add_u32 v6, v6, 4, s44
v_lshl_add_u32 v12, v2, 8, v6
v_add_u32 v6, 12, v2
v_xor_b32 v6, v6, v1
v_lshl_add_u32 v6, v6, 4, s44
v_lshl_add_u32 v13, v2, 8, v6
s_waitcnt lgkmcnt(0)
s_mov_b32 s52, s6
s_mov_b32 s53, s7
s_mov_b32 s54, 67108864
s_mov_b32 s56, s6
s_mov_b32 s57, s7
s_mov_b32 s58, 67108864
s_branch LD_s3
LD_s2:
s_sub_u32 s47, s64, 1
s_add_u32 s48, s48, s64
S_1:
buffer_load_dwordx4 v10, s[52:55], s45 offen offset:0 nt lds
buffer_load_dwordx4 v11, s[52:55], s45 offen offset:1024 nt lds
buffer_load_dwordx4 v12, s[56:59], s45 offen offset:2048 nt lds
buffer_load_dwordx4 v13, s[56:59], s45 offen offset:3072 nt lds
s_add_u32 m0, m0, 4096
s_add_u32 s45, s45, s62
s_and_b32 s45, s45, s63
s_sub_u32 s47, s47, 1
s_cbranch_scc0 S_1
LD_s3:
s_barrier
s_branch LD_cont
L_notloader:
v_mov_b32 v6, 0
v_lshl_add_u32 v7, v0, 2, v3
ds_write_b32 v7, v6
s_sub_u32 s35, s3, 1
s_and_b32 s34, s35, 3
s_mul_i32 s50, s35, 18
s_add_u32 s50, s50, s33
s_sub_u32 s50, s50, 14
s_cmp_lt_u32 s33, 14
s_cbranch_scc1 L_nopf
s_cmp_lt_u32 s32, 3
s_cselect_b32 s51, 0, 44
s_add_u32 s50, s50, s51
s_cmp_ge_u32 s50, 88
s_cbranch_scc1 L_nopf
s_cmp_lt_u32 s50, 44
s_cselect_b32 s51, 0, 44
s_cselect_b32 s52, 5, 7
s_cselect_b32 s53, 54, 64
s_cselect_b32 s54, 6, 8
s_sub_u32 s50, s50, s51
s_lshl_b32 s50, s50, 3
s_add_u32 s50, s50, 224
s_mul_i32 s54, s54, s32
v_lshrrev_b32 v6, 3, v0
v_add_u32 v6, s50, v6
v_and_b32 v7, 7, v0
v_min_u32 v7, s52, v7
v_mul_u32_u24 v6, s53, v6
v_add3_u32 v6, v6, v7, s54
v_lshlrev_b32 v6, 7, v6
s_cmp_eq_u32 s51, 0
s_waitcnt lgkmcnt(0)
s_cselect_b32 s50, s24, s10
s_cselect_b32 s51, s25, s11
global_load_dword v166, v6, s[50:51]
L_nopf:
s_waitcnt lgkmcnt(0)
s_load_dword s40, s[30:31], 0
s_mov_b32 s36, s30
s_mov_b32 s37, s31
s_mov_b32 s38, 8388608
s_mov_b32 s39, 0x20000
s_cmp_ge_u32 s33, 14
s_cbranch_scc1 L_norow
s_cmp_lt_u32 s33, 6
s_cselect_b32 s42, s22, s4
s_cselect_b32 s43, s23, s5
s_cselect_b32 s50, 0, 4
s_and_b32 s51, s35, 4
s_cmp_lg_u32 s50, s51
s_cbranch_scc1 L_norow
s_mul_i32 s50, s34, 1152
v_lshl_add_u32 v6, v0, 3, s50
v_lshl_add_u32 v7, v1, 3, s50
global_load_dwordx2 v[20:21], v6, s[42:43]
global_load_dwordx2 v[22:23], v6, s[42:43] offset:512
global_load_dwordx2 v[24:25], v7, s[42:43] offset:1024
L_norow:
s_barrier
s_waitcnt lgkmcnt(0)
s_add_u32 s40, s40, 0x9e3779b9
s_cmp_ge_u32 s33, 16
s_cbranch_scc1 L_awave
s_branch L_wwave
L_startend:
LD_cont:
v_lshlrev_b32 v15, 2, v0
v_add_u32 v15, 163328, v15
v_cmp_eq_u32 vcc, 0, v0
s_nop 1
v_cndmask_b32 v15, v15, v3, vcc
s_cmp_lt_u32 s33, 16
s_cbranch_scc1 LD_w
s_sub_u32 s47, 32, 1
s_sub_i32 s50, s48, 9
v_mov_b32 v14, s50
s_add_u32 s48, s48, 32
S_2:
v_add_u32 v14, 1, v14
s_waitcnt vmcnt(32)
ds_max_i32 v15, v14
buffer_load_dwordx4 v10, s[52:55], s45 offen offset:0 nt lds
buffer_load_dwordx4 v11, s[52:55], s45 offen offset:1024 nt lds
buffer_load_dwordx4 v12, s[56:59], s45 offen offset:2048 nt lds
buffer_load_dwordx4 v13, s[56:59], s45 offen offset:3072 nt lds
s_add_u32 m0, m0, 4096
s_add_u32 s45, s45, 4096
s_and_b32 s45, s45, 131071
s_sub_u32 s47, s47, 1
s_cbranch_scc0 S_2
v_lshlrev_b32 v6, 1, v2
v_xor_b32 v6, v6, v1
v_lshl_add_u32 v6, v6, 4, s44
v_lshl_add_u32 v10, v2, 8, v6
v_lshlrev_b32 v6, 1, v2
v_xor_b32 v6, v6, v1
v_lshl_add_u32 v6, v6, 4, s44
v_lshl_add_u32 v11, v2, 8, v6
v_lshlrev_b32 v6, 1, v2
v_or_b32 v6, 8, v6
v_xor_b32 v6, v6, v1
v_lshl_add_u32 v6, v6, 4, s44
v_lshl_add_u32 v12, v2, 8, v6
v_lshlrev_b32 v6, 1, v2
v_or_b32 v6, 8, v6
v_xor_b32 v6, v6, v1
v_lshl_add_u32 v6, v6, 4, s44
v_lshl_add_u32 v13, v2, 8, v6
s_mov_b32 s52, s8
s_mov_b32 s53, s9
s_mov_b32 s54, 67108864
s_mov_b32 s56, s8
s_mov_b32 s57, s9
s_mov_b32 s58, 67108864
s_sub_u32 s47, 4, 1
s_sub_i32 s50, s48, 9
v_mov_b32 v14, s50
s_add_u32 s48, s48, 4
S_3:
v_add_u32 v14, 1, v14
s_waitcnt vmcnt(32)
ds_max_i32 v15, v14
buffer_load_dwordx4 v10, s[52:55], s45 offen offset:0 nt lds
buffer_load_dwordx4 v11, s[52:55], s45 offen offset:1024 nt lds
buffer_load_dwordx4 v12, s[56:59], s45 offen offset:2048 nt lds
buffer_load_dwordx4 v13, s[56:59], s45 offen offset:3072 nt lds
s_add_u32 m0, m0, 4096
s_add_u32 s45, s45, 4096
s_and_b32 s45, s45, 131071
s_sub_u32 s47, s47, 1
s_cbranch_scc0 S_3
ds_read_b32 v5, v3 offset:8
s_waitcnt lgkmcnt(0)
v_cmp_le_i32 vcc, 4, v5
s_cbranch_vccnz D_4
s_sub_i32 s50, s48, 9
v_mov_b32 v14, s50
v_add_u32 v14, 1, v14
s_waitcnt vmcnt(32)
ds_max_i32 v15, v14
v_add_u32 v14, 1, v14
s_waitcnt vmcnt(28)
ds_max_i32 v15, v14
v_add_u32 v14, 1, v14
s_waitcnt vmcnt(24)
ds_max_i32 v15, v14
v_add_u32 v14, 1, v14
s_waitcnt vmcnt(20)
ds_max_i32 v15, v14
v_add_u32 v14, 1, v14
s_waitcnt vmcnt(16)
ds_max_i32 v15, v14
v_add_u32 v14, 1, v14
s_waitcnt vmcnt(12)
ds_max_i32 v15, v14
v_add_u32 v14, 1, v14
s_waitcnt vmcnt(8)
ds_max_i32 v15, v14
v_add_u32 v14, 1, v14
s_waitcnt vmcnt(4)
ds_max_i32 v15, v14
v_add_u32 v14, 1, v14
s_waitcnt vmcnt(0)
ds_max_i32 v15, v14
W_5:
ds_read_b32 v5, v3 offset:8
s_waitcnt lgkmcnt(0)
v_cmp_le_i32 vcc, 4, v5
s_cbranch_vccnz D_6
s_sub_u32 s41, s41, 1
s_cbranch_scc1 L_bail
s_sleep 1
s_branch W_5
D_6:
D_4:
s_mov_b32 m0, 0
s_sub_u32 s47, 16, 1
s_sub_i32 s50, s48, 9
v_mov_b32 v14, s50
s_add_u32 s48, s48, 16
S_7:
v_add_u32 v14, 1, v14
s_waitcnt vmcnt(32)
ds_max_i32 v15, v14
buffer_load_dwordx4 v10, s[52:55], s45 offen offset:0 nt lds
buffer_load_dwordx4 v11, s[52:55], s45 offen offset:1024 nt lds
buffer_load_dwordx4 v12, s[56:59], s45 offen offset:2048 nt lds
buffer_load_dwordx4 v13, s[56:59], s45 offen offset:3072 nt lds
s_add_u32 m0, m0, 4096
s_add_u32 s45, s45, 4096
s_and_b32 s45, s45, 131071
s_sub_u32 s47, s47, 1
s_cbranch_scc0 S_7
ds_read_b32 v5, v3 offset:12
s_waitcnt lgkmcnt(0)
v_cmp_le_i32 vcc, 4, v5
s_cbranch_vccnz D_8
s_sub_i32 s50, s48, 9
v_mov_b32 v14, s50
v_add_u32 v14, 1, v14
s_waitcnt vmcnt(32)
ds_max_i32 v15, v14
v_add_u32 v14, 1, v14
s_waitcnt vmcnt(28)
ds_max_i32 v15, v14
v_add_u32 v14, 1, v14
s_waitcnt vmcnt(24)
ds_max_i32 v15, v14
v_add_u32 v14, 1, v14
s_waitcnt vmcnt(20)
ds_max_i32 v15, v14
v_add_u32 v14, 1, v14
s_waitcnt vmcnt(16)
ds_max_i32 v15, v14
v_add_u32 v14, 1, v14
s_waitcnt vmcnt(12)
ds_max_i32 v15, v14
v_add_u32 v14, 1, v14
s_waitcnt vmcnt(8)
ds_max_i32 v15, v14
v_add_u32 v14, 1, v14
s_waitcnt vmcnt(4)
ds_max_i32 v15, v14
v_add_u32 v14, 1, v14
s_waitcnt vmcnt(0)
ds_max_i32 v15, v14
W_9:
ds_read_b32 v5, v3 offset:12
s_waitcnt lgkmcnt(0)
v_cmp_le_i32 vcc, 4, v5
s_cbranch_vccnz D_10
s_sub_u32 s41, s41, 1
s_cbranch_scc1 L_bail
s_sleep 1
s_branch W_9
D_10:
D_8:
s_sub_u32 s47, 12, 1
s_sub_i32 s50, s48, 9
v_mov_b32 v14, s50
s_add_u32 s48, s48, 12
S_11:
v_add_u32 v14, 1, v14
s_waitcnt vmcnt(32)
ds_max_i32 v15, v14
buffer_load_dwordx4 v10, s[52:55], s45 offen offset:0 nt lds
buffer_load_dwordx4 v11, s[52:55], s45 offen offset:1024 nt lds
buffer_load_dwordx4 v12, s[56:59], s45 offen offset:2048 nt lds
buffer_load_dwordx4 v13, s[56:59], s45 offen offset:3072 nt lds
s_add_u32 m0, m0, 4096
s_add_u32 s45, s45, 4096
s_and_b32 s45, s45, 131071
s_sub_u32 s47, s47, 1
s_cbranch_scc0 S_11
s_branch LD_fin
LD_w:
s_waitcnt lgkmcnt(0)
s_cmp_ge_u32 s33, 14
s_cbranch_scc1 LD_nofe
s_cmp_ge_u32 s33, 6
s_cbranch_scc1 LD_fe1
s_cmp_lt_u32 s32, 3
s_cbranch_scc1 LD_fe1
s_sub_u32 s47, 11, 1
s_sub_i32 s50, s48, 7
v_mov_b32 v14, s50
s_add_u32 s48, s48, 11
S_12:
v_add_u32 v14, 1, v14
s_waitcnt vmcnt(24)
ds_max_i32 v15, v14
buffer_load_dwordx4 v10, s[52:55], s45 offen offset:0 nt lds
buffer_load_dwordx4 v11, s[52:55], s45 offen offset:1024 nt lds
buffer_load_dwordx4 v12, s[56:59], s45 offen offset:2048 nt lds
buffer_load_dwordx4 v13, s[56:59], s45 offen offset:3072 nt lds
s_add_u32 m0, m0, 4096
s_add_u32 s45, s45, s62
s_sub_u32 s47, s47, 1
s_cbranch_scc0 S_12
s_branch LD_late
LD_fe1:
s_sub_u32 s47, 11, 1
s_sub_i32 s50, s48, 8
v_mov_b32 v14, s50
s_add_u32 s48, s48, 11
S_13:
v_add_u32 v14, 1, v14
s_waitcnt vmcnt(28)
ds_max_i32 v15, v14
buffer_load_dwordx4 v10, s[52:55], s45 offen offset:0 nt lds
buffer_load_dwordx4 v11, s[52:55], s45 offen offset:1024 nt lds
buffer_load_dwordx4 v12, s[56:59], s45 offen offset:2048 nt lds
buffer_load_dwordx4 v13, s[56:59], s45 offen offset:3072 nt lds
s_add_u32 m0, m0, 4096
s_add_u32 s45, s45, s62
s_sub_u32 s47, s47, 1
s_cbranch_scc0 S_13
s_sub_i32 s50, s48, 8
v_mov_b32 v14, s50
v_add_u32 v14, 1, v14
s_waitcnt vmcnt(28)
ds_max_i32 v15, v14
v_add_u32 v14, 1, v14
s_waitcnt vmcnt(24)
ds_max_i32 v15, v14
v_add_u32 v14, 1, v14
s_waitcnt vmcnt(20)
ds_max_i32 v15, v14
v_add_u32 v14, 1, v14
s_waitcnt vmcnt(16)
ds_max_i32 v15, v14
v_add_u32 v14, 1, v14
s_waitcnt vmcnt(12)
ds_max_i32 v15, v14
v_add_u32 v14, 1, v14
s_waitcnt vmcnt(8)
ds_max_i32 v15, v14
v_add_u32 v14, 1, v14
s_waitcnt vmcnt(4)
ds_max_i32 v15, v14
v_add_u32 v14, 1, v14
s_waitcnt vmcnt(0)
ds_max_i32 v15, v14
W_14:
ds_read_b32 v5, v3 offset:56
s_waitcnt lgkmcnt(0)
v_cmp_le_i32 vcc, 4, v5
s_cbranch_vccnz D_15
s_sub_u32 s41, s41, 1
s_cbranch_scc1 L_bail
s_sleep 1
s_branch W_14
D_15:
s_branch LD_late
LD_nofe:
s_mov_b32 s48, 18
LD_late:
s_cmp_lt_u32 s33, 6
s_cbranch_scc1 LD_mlp
s_cmp_ge_u32 s33, 13
s_cbranch_scc1 LD_mlp
s_cmp_eq_u32 s33, 12
s_cbranch_scc1 LD_gb
s_mov_b32 s61, 1152
v_lshrrev_b32 v6, 3, v0
v_and_b32 v7, 2, v6
v_and_b32 v8, 7, v0
v_xor_b32 v7, v7, v8
v_lshlrev_b32 v7, 4, v7
v_mul_lo_u32 v6, v6, s61
s_lshl_b32 s50, s61, 3
s_sub_u32 s50, s50, 1024
v_add_u32 v10, v6, v7
v_xor_b32 v7, 64, v7
v_add3_u32 v11, v6, v7, s50
s_lshl_b32 s50, s50, 1
v_add_u32 v12, s50, v10
v_add_u32 v13, s50, v11
s_mov_b32 s52, s12
s_mov_b32 s53, s13
s_mov_b32 s54, 4718592
s_mov_b32 s56, s12
s_mov_b32 s57, s13
s_mov_b32 s58, 4718592
s_sub_u32 s63, s33, 6
s_and_b32 s44, s63, 1
s_lshl_b32 s50, s32, 1
s_add_u32 s44, s44, s50
s_mul_i32 s44, s44, 294912
s_lshr_b32 s50, s63, 1
s_mul_i32 s50, s50, 384
s_add_u32 s44, s44, s50
s_mov_b32 m0, 0
s_mov_b32 s63, 0
s_mov_b32 s45, s44
LD_wo:
s_cmp_lg_u32 s63, 6
s_cbranch_scc1 LD_wo1
ds_read_b32 v5, v3 offset:4
s_waitcnt lgkmcnt(0)
v_cmp_le_i32 vcc, 4, v5
s_cbranch_vccnz D_16
s_sub_i32 s50, s48, 8
v_mov_b32 v14, s50
v_add_u32 v14, 1, v14
s_waitcnt vmcnt(28)
ds_max_i32 v15, v14
v_add_u32 v14, 1, v14
s_waitcnt vmcnt(24)
ds_max_i32 v15, v14
v_add_u32 v14, 1, v14
s_waitcnt vmcnt(20)
ds_max_i32 v15, v14
v_add_u32 v14, 1, v14
s_waitcnt vmcnt(16)
ds_max_i32 v15, v14
v_add_u32 v14, 1, v14
s_waitcnt vmcnt(12)
ds_max_i32 v15, v14
v_add_u32 v14, 1, v14
s_waitcnt vmcnt(8)
ds_max_i32 v15, v14
v_add_u32 v14, 1, v14
s_waitcnt vmcnt(4)
ds_max_i32 v15, v14
v_add_u32 v14, 1, v14
s_waitcnt vmcnt(0)
ds_max_i32 v15, v14
W_17:
ds_read_b32 v5, v3 offset:4
s_waitcnt lgkmcnt(0)
v_cmp_le_i32 vcc, 4, v5
s_cbranch_vccnz D_18
s_sub_u32 s41, s41, 1
s_cbranch_scc1 L_bail
s_sleep 1
s_branch W_17
D_18:
D_16:
LD_wo1:
s_sub_u32 s47, 3, 1
s_sub_i32 s50, s48, 8
v_mov_b32 v14, s50
s_add_u32 s48, s48, 3
S_19:
v_add_u32 v14, 1, v14
s_waitcnt vmcnt(28)
ds_max_i32 v15, v14
buffer_load_dwordx4 v10, s[52:55], s45 offen offset:0 nt lds
buffer_load_dwordx4 v11, s[52:55], s45 offen offset:1024 nt lds
buffer_load_dwordx4 v12, s[56:59], s45 offen offset:2048 nt lds
buffer_load_dwordx4 v13, s[56:59], s45 offen offset:3072 nt lds
s_add_u32 m0, m0, 4096
s_add_u32 s45, s45, 128
s_sub_u32 s47, s47, 1
s_cbranch_scc0 S_19
s_add_u32 s45, s45, 36480
s_add_u32 s63, s63, 1
s_cmp_lt_u32 s63, 8
s_cbranch_scc1 LD_wo
s_branch LD_fin
LD_gb:
s_cmp_ge_u32 s32, 6
s_cbranch_scc1 LD_fin
s_mov_b32 s61, 6912
v_lshrrev_b32 v6, 3, v0
v_and_b32 v7, 2, v6
v_and_b32 v8, 7, v0
v_xor_b32 v7, v7, v8
v_lshlrev_b32 v7, 4, v7
v_mul_lo_u32 v6, v6, s61
s_lshl_b32 s50, s61, 3
s_sub_u32 s50, s50, 1024
v_add_u32 v10, v6, v7
v_xor_b32 v7, 64, v7
v_add3_u32 v11, v6, v7, s50
s_lshl_b32 s50, s50, 1
v_add_u32 v12, s50, v10
v_add_u32 v13, s50, v11
s_mov_b32 s52, s24
s_mov_b32 s53, s25
s_mov_b32 s54, 3981312
s_mov_b32 s56, s24
s_mov_b32 s57, s25
s_mov_b32 s58, 3981312
s_add_u32 s45, s32, 48
s_lshl_b32 s45, s45, 7
s_mov_b32 m0, 0
s_sub_u32 s47, 18, 1
s_sub_i32 s50, s48, 7
v_mov_b32 v14, s50
s_add_u32 s48, s48, 18
S_20:
v_add_u32 v14, 1, v14
s_waitcnt vmcnt(24)
ds_max_i32 v15, v14
buffer_load_dwordx4 v10, s[52:55], s45 offen offset:0 nt lds
buffer_load_dwordx4 v11, s[52:55], s45 offen offset:1024 nt lds
buffer_load_dwordx4 v12, s[56:59], s45 offen offset:2048 nt lds
buffer_load_dwordx4 v13, s[56:59], s45 offen offset:3072 nt lds
s_add_u32 m0, m0, 4096
s_add_u32 s45, s45, 221184
s_sub_u32 s47, s47, 1
s_cbranch_scc0 S_20
s_branch LD_fin
LD_mlp:
s_cmp_eq_u32 s33, 15
s_cselect_b32 s62, 6, s33
s_cmp_gt_u32 s62, 6
s_cbranch_scc1 LD_noas
s_sub_i32 s50, s48, 7
v_mov_b32 v14, s50
v_add_u32 v14, 1, v14
s_waitcnt vmcnt(24)
ds_max_i32 v15, v14
v_add_u32 v14, 1, v14
s_waitcnt vmcnt(20)
ds_max_i32 v15, v14
v_add_u32 v14, 1, v14
s_waitcnt vmcnt(16)
ds_max_i32 v15, v14
v_add_u32 v14, 1, v14
s_waitcnt vmcnt(12)
ds_max_i32 v15, v14
v_add_u32 v14, 1, v14
s_waitcnt vmcnt(8)
ds_max_i32 v15, v14
v_add_u32 v14, 1, v14
s_waitcnt vmcnt(4)
ds_max_i32 v15, v14
v_add_u32 v14, 1, v14
s_waitcnt vmcnt(0)
ds_max_i32 v15, v14
v_lshlrev_b32 v6, 7, v0
LD_as:
s_and_b32 s50, s62, 15
s_lshr_b32 s51, s62, 4
s_lshl_b32 s63, s50, 3
s_add_u32 s63, s63, s32
s_add_u32 s63, s63, 128
s_mul_i32 s63, s63, 5
s_lshl_b32 s63, s63, 12
s_add_u32 s51, s51, 12
s_lshl_b32 s51, s51, 13
s_add_u32 s63, s63, s51
v_add_u32 v7, s63, v6
v_and_b32 v7, 0x1ffff, v7
s_bfe_u32 s51, s50, 0x20001
s_lshl_b32 s51, s51, 24
s_and_b32 s63, s50, 1
s_lshl_b32 s63, s63, 17
s_add_u32 s51, s51, s63
s_lshr_b32 s50, s50, 3
s_lshl_b32 s63, s32, 1
s_add_u32 s50, s50, s63
s_lshl_b32 s50, s50, 20
s_add_u32 s51, s51, s50
s_add_u32 s51, s51, 786432
v_add_u32 v7, s51, v7
s_waitcnt vmcnt(3)
global_load_dword v20, v7, s[8:9]
s_add_u32 s62, s62, 7
s_cmp_lt_u32 s62, 64
s_cbranch_scc1 LD_as
LD_noas:
s_add_u32 s62, s33, 1
s_cmp_eq_u32 s33, 13
s_cselect_b32 s62, 7, s62
s_cmp_eq_u32 s33, 14
s_cselect_b32 s62, 0, s62
s_cmp_eq_u32 s33, 15
s_cselect_b32 s62, 8, s62
s_sub_u32 s50, 3, s32
s_and_b32 s50, s50, 7
s_add_u32 s50, s50, s62
s_cmp_ge_u32 s50, 9
s_cselect_b32 s51, 9, 0
s_sub_u32 s50, s50, s51
s_mul_i32 s63, s32, 9
s_add_u32 s63, s63, s50
v_lshrrev_b32 v6, 3, v0
v_bfe_u32 v7, v0, 4, 1
v_and_b32 v8, 7, v0
v_xor_b32 v7, v7, v8
v_lshlrev_b32 v7, 4, v7
v_mul_u32_u24 v6, 9216, v6
v_xor_b32 v8, 0, v7
v_add_u32 v8, v8, v6
v_add_u32 v10, 4096, v8
v_xor_b32 v8, 32, v7
v_add_u32 v8, v8, v6
v_add_u32 v11, 76800, v8
v_xor_b32 v8, 64, v7
v_add_u32 v8, v8, v6
v_add_u32 v12, 2048, v8
v_xor_b32 v8, 96, v7
v_add_u32 v8, v8, v6
v_add_u32 v13, 74752, v8
s_sub_u32 s52, s16, 4096
s_subb_u32 s53, s17, 0
s_mov_b32 s54, 5312512
s_sub_u32 s56, s18, 4096
s_subb_u32 s57, s19, 0
s_mov_b32 s58, 5312512
s_lshl_b32 s45, s63, 7
s_mov_b32 m0, 0
s_mov_b32 s64, 18
s_cmp_lg_u32 s33, 13
s_cbranch_scc1 LD_m1
LD_m0:
s_sub_u32 s47, 3, 1
s_sub_i32 s50, s48, 8
v_mov_b32 v14, s50
s_add_u32 s48, s48, 3
S_21:
v_add_u32 v14, 1, v14
s_waitcnt vmcnt(28)
ds_max_i32 v15, v14
buffer_load_dwordx4 v10, s[52:55], s45 offen offset:0 nt lds
buffer_load_dwordx4 v11, s[52:55], s45 offen offset:1024 nt lds
buffer_load_dwordx4 v12, s[56:59], s45 offen offset:2048 nt lds
buffer_load_dwordx4 v13, s[56:59], s45 offen offset:3072 nt lds
s_add_u32 m0, m0, 4096
s_add_u32 s45, s45, 147456
s_sub_u32 s47, s47, 1
s_cbranch_scc0 S_21
s_sub_u32 s64, s64, 3
s_cmp_lg_u32 s64, 0
s_cbranch_scc1 LD_m0
s_branch LD_m3
LD_m1:
s_sub_u32 s47, 12, 1
s_sub_i32 s50, s48, 7
v_mov_b32 v14, s50
s_add_u32 s48, s48, 12
S_22:
v_add_u32 v14, 1, v14
s_waitcnt vmcnt(24)
ds_max_i32 v15, v14
buffer_load_dwordx4 v10, s[52:55], s45 offen offset:0 nt lds
buffer_load_dwordx4 v11, s[52:55], s45 offen offset:1024 nt lds
buffer_load_dwordx4 v12, s[56:59], s45 offen offset:2048 nt lds
buffer_load_dwordx4 v13, s[56:59], s45 offen offset:3072 nt lds
s_add_u32 m0, m0, 4096
s_add_u32 s45, s45, 147456
s_sub_u32 s47, s47, 1
s_cbranch_scc0 S_22
s_sub_u32 s47, 6, 1
s_sub_i32 s50, s48, 8
v_mov_b32 v14, s50
s_add_u32 s48, s48, 6
S_23:
v_add_u32 v14, 1, v14
s_waitcnt vmcnt(28)
ds_max_i32 v15, v14
buffer_load_dwordx4 v10, s[52:55], s45 offen offset:0 nt lds
buffer_load_dwordx4 v11, s[52:55], s45 offen offset:1024 nt lds
buffer_load_dwordx4 v12, s[56:59], s45 offen offset:2048 nt lds
buffer_load_dwordx4 v13, s[56:59], s45 offen offset:3072 nt lds
s_add_u32 m0, m0, 4096
s_add_u32 s45, s45, 147456
s_sub_u32 s47, s47, 1
s_cbranch_scc0 S_23
LD_m3:
ds_read_b32 v5, v3 offset:76
s_waitcnt lgkmcnt(0)
v_cmp_le_i32 vcc, 4, v5
s_cbranch_vccnz D_24
s_sub_i32 s50, s48, 8
v_mov_b32 v14, s50
v_add_u32 v14, 1, v14
s_waitcnt vmcnt(28)
ds_max_i32 v15, v14
v_add_u32 v14, 1, v14
s_waitcnt vmcnt(24)
ds_max_i32 v15, v14
v_add_u32 v14, 1, v14
s_waitcnt vmcnt(20)
ds_max_i32 v15, v14
v_add_u32 v14, 1, v14
s_waitcnt vmcnt(16)
ds_max_i32 v15, v14
v_add_u32 v14, 1, v14
s_waitcnt vmcnt(12)
ds_max_i32 v15, v14
v_add_u32 v14, 1, v14
s_waitcnt vmcnt(8)
ds_max_i32 v15, v14
v_add_u32 v14, 1, v14
s_waitcnt vmcnt(4)
ds_max_i32 v15, v14
v_add_u32 v14, 1, v14
s_waitcnt vmcnt(0)
ds_max_i32 v15, v14
W_25:
ds_read_b32 v5, v3 offset:76
s_waitcnt lgkmcnt(0)
v_cmp_le_i32 vcc, 4, v5
s_cbranch_vccnz D_26
s_sub_u32 s41, s41, 1
s_cbranch_scc1 L_bail
s_sleep 1
s_branch W_25
D_26:
D_24:
s_sub_u32 s47, 18, 1
s_sub_i32 s50, s48, 8
v_mov_b32 v14, s50
s_add_u32 s48, s48, 18
S_27:
v_add_u32 v14, 1, v14
s_waitcnt vmcnt(28)
ds_max_i32 v15, v14
buffer_load_dwordx4 v10, s[52:55], s45 offen offset:0 nt lds
buffer_load_dwordx4 v11, s[52:55], s45 offen offset:1024 nt lds
buffer_load_dwordx4 v12, s[56:59], s45 offen offset:2048 nt lds
buffer_load_dwordx4 v13, s[56:59], s45 offen offset:3072 nt lds
s_add_u32 m0, m0, 4096
s_add_u32 s45, s45, 147456
s_sub_u32 s47, s47, 1
s_cbranch_scc0 S_27
s_mov_b32 s61, 1152
v_lshrrev_b32 v6, 3, v0
v_and_b32 v7, 2, v6
v_and_b32 v8, 7, v0
v_xor_b32 v7, v7, v8
v_lshlrev_b32 v7, 4, v7
v_mul_lo_u32 v6, v6, s61
s_lshl_b32 s50, s61, 3
s_sub_u32 s50, s50, 1024
v_add_u32 v10, v6, v7
v_xor_b32 v7, 64, v7
v_add3_u32 v11, v6, v7, s50
s_lshl_b32 s50, s50, 1
v_add_u32 v12, s50, v10
v_add_u32 v13, s50, v11
s_mov_b32 s52, s20
s_mov_b32 s53, s21
s_mov_b32 s54, 5308416
s_mov_b32 s56, s20
s_mov_b32 s57, s21
s_mov_b32 s58, 5308416
s_mul_i32 s45, s63, 73728
ds_read_b32 v5, v3 offset:80
s_waitcnt lgkmcnt(0)
v_cmp_le_i32 vcc, 8, v5
s_cbranch_vccnz D_28
s_sub_i32 s50, s48, 8
v_mov_b32 v14, s50
v_add_u32 v14, 1, v14
s_waitcnt vmcnt(28)
ds_max_i32 v15, v14
v_add_u32 v14, 1, v14
s_waitcnt vmcnt(24)
ds_max_i32 v15, v14
v_add_u32 v14, 1, v14
s_waitcnt vmcnt(20)
ds_max_i32 v15, v14
v_add_u32 v14, 1, v14
s_waitcnt vmcnt(16)
ds_max_i32 v15, v14
v_add_u32 v14, 1, v14
s_waitcnt vmcnt(12)
ds_max_i32 v15, v14
v_add_u32 v14, 1, v14
s_waitcnt vmcnt(8)
ds_max_i32 v15, v14
v_add_u32 v14, 1, v14
s_waitcnt vmcnt(4)
ds_max_i32 v15, v14
v_add_u32 v14, 1, v14
s_waitcnt vmcnt(0)
ds_max_i32 v15, v14
W_29:
ds_read_b32 v5, v3 offset:80
s_waitcnt lgkmcnt(0)
v_cmp_le_i32 vcc, 8, v5
s_cbranch_vccnz D_30
s_sub_u32 s41, s41, 1
s_cbranch_scc1 L_bail
s_sleep 1
s_branch W_29
D_30:
D_28:
s_mov_b32 m0, 0
s_sub_u32 s47, 9, 1
s_sub_i32 s50, s48, 8
v_mov_b32 v14, s50
s_add_u32 s48, s48, 9
S_31:
v_add_u32 v14, 1, v14
s_waitcnt vmcnt(28)
ds_max_i32 v15, v14
buffer_load_dwordx4 v10, s[52:55], s45 offen offset:0 nt lds
buffer_load_dwordx4 v11, s[52:55], s45 offen offset:1024 nt lds
buffer_load_dwordx4 v12, s[56:59], s45 offen offset:2048 nt lds
buffer_load_dwordx4 v13, s[56:59], s45 offen offset:3072 nt lds
s_add_u32 m0, m0, 4096
s_add_u32 s45, s45, 128
s_sub_u32 s47, s47, 1
s_cbranch_scc0 S_31
s_add_u32 s45, s45, 35712
s_sub_u32 s47, 9, 1
s_sub_i32 s50, s48, 8
v_mov_b32 v14, s50
s_add_u32 s48, s48, 9
S_32:
v_add_u32 v14, 1, v14
s_waitcnt vmcnt(28)
ds_max_i32 v15, v14
buffer_load_dwordx4 v10, s[52:55], s45 offen offset:0 nt lds
buffer_load_dwordx4 v11, s[52:55], s45 offen offset:1024 nt lds
buffer_load_dwordx4 v12, s[56:59], s45 offen offset:2048 nt lds
buffer_load_dwordx4 v13, s[56:59], s45 offen offset:3072 nt lds
s_add_u32 m0, m0, 4096
s_add_u32 s45, s45, 128
s_sub_u32 s47, s47, 1
s_cbranch_scc0 S_32
LD_fin:
s_sub_i32 s50, s48, 9
v_mov_b32 v14, s50
v_add_u32 v14, 1, v14
s_waitcnt vmcnt(32)
ds_max_i32 v15, v14
v_add_u32 v14, 1, v14
s_waitcnt vmcnt(28)
ds_max_i32 v15, v14
v_add_u32 v14, 1, v14
s_waitcnt vmcnt(24)
ds_max_i32 v15, v14
v_add_u32 v14, 1, v14
s_waitcnt vmcnt(20)
ds_max_i32 v15, v14
v_add_u32 v14, 1, v14
s_waitcnt vmcnt(16)
ds_max_i32 v15, v14
v_add_u32 v14, 1, v14
s_waitcnt vmcnt(12)
ds_max_i32 v15, v14
v_add_u32 v14, 1, v14
s_waitcnt vmcnt(8)
ds_max_i32 v15, v14
v_add_u32 v14, 1, v14
s_waitcnt vmcnt(4)
ds_max_i32 v15, v14
v_add_u32 v14, 1, v14
s_waitcnt vmcnt(0)
ds_max_i32 v15, v14
s_branch L_exit
L_wwave:
s_cmp_ge_u32 s33, 14
s_cbranch_scc1 W_fed
s_cmp_ge_u32 s33, 6
s_cbranch_scc1 W_q
s_cmp_ge_u32 s35, 4
s_cbranch_scc1 W_post
s_mul_i32 s64, s32, 6
s_add_u32 s64, s64, s33
s_mul_i32 s50, s34, 1344
s_add_u32 s50, s50, 151552
v_lshl_add_u32 v8, v0, 3, s50
v_lshl_add_u32 v9, v1, 3, s50
v_lshrrev_b32 v6, 3, v1
v_and_b32 v7, 1, v2
v_lshl_or_b32 v6, v7, 1, v6
v_xor_b32 v6, s34, v6
v_lshlrev_b32 v6, 5, v6
v_lshrrev_b32 v7, 2, v1
v_lshl_add_u32 v7, v2, 3, v7
v_lshl_add_u32 v6, v7, 7, v6
v_and_b32 v7, 3, v1
v_lshl_add_u32 v6, v7, 3, v6
v_add_u32 v16, 73728, v6
v_add_u32 v17, 36864, v16
v_and_b32 v6, 3, v1
v_mul_u32_u24 v6, 1344, v6
v_lshl_add_u32 v6, v2, 4, v6
v_add_u32 v18, 151552, v6
s_waitcnt vmcnt(0)
v_lshlrev_b32 v28, 16, v20
v_and_b32 v29, 0xffff0000, v20
v_lshlrev_b32 v30, 16, v21
v_and_b32 v31, 0xffff0000, v21
v_lshlrev_b32 v32, 16, v22
v_and_b32 v33, 0xffff0000, v22
v_lshlrev_b32 v34, 16, v23
v_and_b32 v35, 0xffff0000, v23
v_lshlrev_b32 v36, 16, v24
v_and_b32 v37, 0xffff0000, v24
v_lshlrev_b32 v38, 16, v25
v_and_b32 v39, 0xffff0000, v25
v_mul_f32 v40, 0xbfb8aa3b, v28
v_min_f32 v40, 0x42f00000, v40
v_exp_f32 v40, v40
v_mul_f32 v41, 0xbfb8aa3b, v29
v_min_f32 v41, 0x42f00000, v41
v_exp_f32 v41, v41
v_mul_f32 v42, 0xbfb8aa3b, v30
v_min_f32 v42, 0x42f00000, v42
v_exp_f32 v42, v42
v_mul_f32 v43, 0xbfb8aa3b, v31
v_min_f32 v43, 0x42f00000, v43
v_exp_f32 v43, v43
v_mul_f32 v44, 0xbfb8aa3b, v32
v_min_f32 v44, 0x42f00000, v44
v_exp_f32 v44, v44
v_mul_f32 v45, 0xbfb8aa3b, v33
v_min_f32 v45, 0x42f00000, v45
v_exp_f32 v45, v45
v_mul_f32 v46, 0xbfb8aa3b, v34
v_min_f32 v46, 0x42f00000, v46
v_exp_f32 v46, v46
v_mul_f32 v47, 0xbfb8aa3b, v35
v_min_f32 v47, 0x42f00000, v47
v_exp_f32 v47, v47
v_mul_f32 v48, 0xbfb8aa3b, v36
v_min_f32 v48, 0x42f00000, v48
v_exp_f32 v48, v48
v_mul_f32 v49, 0xbfb8aa3b, v37
v_min_f32 v49, 0x42f00000, v49
v_exp_f32 v49, v49
v_mul_f32 v50, 0xbfb8aa3b, v38
v_min_f32 v50, 0x42f00000, v50
v_exp_f32 v50, v50
v_mul_f32 v51, 0xbfb8aa3b, v39
v_min_f32 v51, 0x42f00000, v51
v_exp_f32 v51, v51
v_add_f32 v40, 1.0, v40
v_rcp_f32 v52, v40
v_add_f32 v41, 1.0, v41
v_rcp_f32 v53, v41
v_add_f32 v42, 1.0, v42
v_rcp_f32 v54, v42
v_add_f32 v43, 1.0, v43
v_rcp_f32 v55, v43
v_add_f32 v44, 1.0, v44
v_rcp_f32 v56, v44
v_add_f32 v45, 1.0, v45
v_rcp_f32 v57, v45
v_add_f32 v46, 1.0, v46
v_rcp_f32 v58, v46
v_add_f32 v47, 1.0, v47
v_rcp_f32 v59, v47
v_add_f32 v48, 1.0, v48
v_rcp_f32 v60, v48
v_add_f32 v49, 1.0, v49
v_rcp_f32 v61, v49
v_add_f32 v50, 1.0, v50
v_rcp_f32 v62, v50
v_add_f32 v51, 1.0, v51
v_rcp_f32 v63, v51
v_mul_f32 v64, v28, v52
v_fma_f32 v40, -v64, v40, v28
v_fma_f32 v64, v40, v52, v64
v_mul_f32 v65, v29, v53
v_fma_f32 v41, -v65, v41, v29
v_fma_f32 v65, v41, v53, v65
v_mul_f32 v66, v30, v54
v_fma_f32 v42, -v66, v42, v30
v_fma_f32 v66, v42, v54, v66
v_mul_f32 v67, v31, v55
v_fma_f32 v43, -v67, v43, v31
v_fma_f32 v67, v43, v55, v67
v_mul_f32 v68, v32, v56
v_fma_f32 v44, -v68, v44, v32
v_fma_f32 v68, v44, v56, v68
v_mul_f32 v69, v33, v57
v_fma_f32 v45, -v69, v45, v33
v_fma_f32 v69, v45, v57, v69
v_mul_f32 v70, v34, v58
v_fma_f32 v46, -v70, v46, v34
v_fma_f32 v70, v46, v58, v70
v_mul_f32 v71, v35, v59
v_fma_f32 v47, -v71, v47, v35
v_fma_f32 v71, v47, v59, v71
v_mul_f32 v72, v36, v60
v_fma_f32 v48, -v72, v48, v36
v_fma_f32 v72, v48, v60, v72
v_mul_f32 v73, v37, v61
v_fma_f32 v49, -v73, v49, v37
v_fma_f32 v73, v49, v61, v73
v_mul_f32 v74, v38, v62
v_fma_f32 v50, -v74, v50, v38
v_fma_f32 v74, v50, v62, v74
v_mul_f32 v75, v39, v63
v_fma_f32 v51, -v75, v51, v39
v_fma_f32 v75, v51, v63, v75
v_cvt_pk_bf16_f32 v20, v64, v65
v_cvt_pk_bf16_f32 v21, v66, v67
v_cvt_pk_bf16_f32 v22, v68, v69
v_cvt_pk_bf16_f32 v23, v70, v71
v_cvt_pk_bf16_f32 v24, v72, v73
v_cvt_pk_bf16_f32 v25, v74, v75
ds_write_b64 v8, v[20:21]
ds_write_b64 v8, v[22:23] offset:512
ds_write_b64 v9, v[24:25] offset:1024
s_mov_b64 exec, 1
ds_add_u32 v3, v4 offset:28
s_mov_b64 exec, -1
W_33:
ds_read_b32 v5, v3 offset:28
s_waitcnt lgkmcnt(0)
v_cmp_le_i32 vcc, 4, v5
s_cbranch_vccnz D_34
s_sub_u32 s41, s41, 1
s_cbranch_scc1 L_bail
s_sleep 1
s_branch W_33
D_34:
ds_read_b128 v[32:35], v18 offset:0
ds_read_b128 v[36:39], v18 offset:64
ds_read_b128 v[40:43], v18 offset:128
ds_read_b128 v[44:47], v18 offset:192
ds_read_b128 v[48:51], v18 offset:256
ds_read_b128 v[52:55], v18 offset:320
ds_read_b128 v[56:59], v18 offset:384
ds_read_b128 v[60:63], v18 offset:448
ds_read_b128 v[64:67], v18 offset:512
ds_read_b128 v[68:71], v18 offset:576
ds_read_b128 v[72:75], v18 offset:640
ds_read_b128 v[76:79], v18 offset:704
ds_read_b128 v[80:83], v18 offset:768
ds_read_b128 v[84:87], v18 offset:832
ds_read_b128 v[88:91], v18 offset:896
ds_read_b128 v[92:95], v18 offset:960
ds_read_b128 v[96:99], v18 offset:1024
ds_read_b128 v[100:103], v18 offset:1088
W_35:
ds_read_b32 v5, v3 offset:0
s_waitcnt lgkmcnt(0)
v_cmp_le_i32 vcc, 6, v5
s_cbranch_vccnz D_36
s_sub_u32 s41, s41, 1
s_cbranch_scc1 L_bail
s_branch W_35
D_36:
ds_read_b64_tr_b16 v[104:105], v16 offset:0
ds_read_b64_tr_b16 v[106:107], v16 offset:512
ds_read_b64_tr_b16 v[108:109], v16 offset:4096
ds_read_b64_tr_b16 v[110:111], v16 offset:4608
ds_read_b64_tr_b16 v[112:113], v16 offset:8192
ds_read_b64_tr_b16 v[114:115], v16 offset:8704
ds_read_b64_tr_b16 v[116:117], v16 offset:12288
ds_read_b64_tr_b16 v[118:119], v16 offset:12800
ds_read_b64_tr_b16 v[120:121], v16 offset:16384
ds_read_b64_tr_b16 v[122:123], v16 offset:16896
ds_read_b64_tr_b16 v[124:125], v16 offset:20480
ds_read_b64_tr_b16 v[126:127], v16 offset:20992
s_waitcnt lgkmcnt(10)
v_mfma_f32_16x16x32_bf16 v[20:23], v[104:107], v[32:35], 0
s_waitcnt lgkmcnt(8)
v_mfma_f32_16x16x32_bf16 v[20:23], v[108:111], v[36:39], v[20:23]
s_waitcnt lgkmcnt(6)
v_mfma_f32_16x16x32_bf16 v[20:23], v[112:115], v[40:43], v[20:23]
s_waitcnt lgkmcnt(4)
v_mfma_f32_16x16x32_bf16 v[20:23], v[116:119], v[44:47], v[20:23]
s_waitcnt lgkmcnt(2)
v_mfma_f32_16x16x32_bf16 v[20:23], v[120:123], v[48:51], v[20:23]
s_waitcnt lgkmcnt(0)
v_mfma_f32_16x16x32_bf16 v[20:23], v[124:127], v[52:55], v[20:23]
W_37:
ds_read_b32 v5, v3 offset:0
s_waitcnt lgkmcnt(0)
v_cmp_le_i32 vcc, 12, v5
s_cbranch_vccnz D_38
s_sub_u32 s41, s41, 1
s_cbranch_scc1 L_bail
s_branch W_37
D_38:
ds_read_b64_tr_b16 v[104:105], v16 offset:24576
ds_read_b64_tr_b16 v[106:107], v16 offset:25088
ds_read_b64_tr_b16 v[108:109], v16 offset:28672
ds_read_b64_tr_b16 v[110:111], v16 offset:29184
ds_read_b64_tr_b16 v[112:113], v16 offset:32768
ds_read_b64_tr_b16 v[114:115], v16 offset:33280
ds_read_b64_tr_b16 v[116:117], v17 offset:0
ds_read_b64_tr_b16 v[118:119], v17 offset:512
ds_read_b64_tr_b16 v[120:121], v17 offset:4096
ds_read_b64_tr_b16 v[122:123], v17 offset:4608
ds_read_b64_tr_b16 v[124:125], v17 offset:8192
ds_read_b64_tr_b16 v[126:127], v17 offset:8704
s_waitcnt lgkmcnt(10)
v_mfma_f32_16x16x32_bf16 v[20:23], v[104:107], v[56:59], v[20:23]
s_waitcnt lgkmcnt(8)
v_mfma_f32_16x16x32_bf16 v[20:23], v[108:111], v[60:63], v[20:23]
s_waitcnt lgkmcnt(6)
v_mfma_f32_16x16x32_bf16 v[20:23], v[112:115], v[64:67], v[20:23]
s_waitcnt lgkmcnt(4)
v_mfma_f32_16x16x32_bf16 v[20:23], v[116:119], v[68:71], v[20:23]
s_waitcnt lgkmcnt(2)
v_mfma_f32_16x16x32_bf16 v[20:23], v[120:123], v[72:75], v[20:23]
s_waitcnt lgkmcnt(0)
v_mfma_f32_16x16x32_bf16 v[20:23], v[124:127], v[76:79], v[20:23]
W_39:
ds_read_b32 v5, v3 offset:0
s_waitcnt lgkmcnt(0)
v_cmp_le_i32 vcc, 18, v5
s_cbranch_vccnz D_40
s_sub_u32 s41, s41, 1
s_cbranch_scc1 L_bail
s_branch W_39
D_40:
ds_read_b64_tr_b16 v[104:105], v17 offset:12288
ds_read_b64_tr_b16 v[106:107], v17 offset:12800
ds_read_b64_tr_b16 v[108:109], v17 offset:16384
ds_read_b64_tr_b16 v[110:111], v17 offset:16896
ds_read_b64_tr_b16 v[112:113], v17 offset:20480
ds_read_b64_tr_b16 v[114:115], v17 offset:20992
ds_read_b64_tr_b16 v[116:117], v17 offset:24576
ds_read_b64_tr_b16 v[118:119], v17 offset:25088
ds_read_b64_tr_b16 v[120:121], v17 offset:28672
ds_read_b64_tr_b16 v[122:123], v17 offset:29184
ds_read_b64_tr_b16 v[124:125], v17 offset:32768
ds_read_b64_tr_b16 v[126:127], v17 offset:33280
s_waitcnt lgkmcnt(10)
v_mfma_f32_16x16x32_bf16 v[20:23], v[104:107], v[80:83], v[20:23]
s_waitcnt lgkmcnt(8)
v_mfma_f32_16x16x32_bf16 v[20:23], v[108:111], v[84:87], v[20:23]
s_waitcnt lgkmcnt(6)
v_mfma_f32_16x16x32_bf16 v[20:23], v[112:115], v[88:91], v[20:23]
s_waitcnt lgkmcnt(4)
v_mfma_f32_16x16x32_bf16 v[20:23], v[116:119], v[92:95], v[20:23]
s_waitcnt lgkmcnt(2)
v_mfma_f32_16x16x32_bf16 v[20:23], v[120:123], v[96:99], v[20:23]
s_waitcnt lgkmcnt(0)
v_mfma_f32_16x16x32_bf16 v[20:23], v[124:127], v[100:103], v[20:23]
s_lshl_b32 s50, s34, 5
s_add_u32 s50, s50, 157056
v_lshlrev_b32 v8, 7, v1
v_lshl_add_u32 v8, v2, 3, v8
v_add_u32 v8, s50, v8
v_mul_u32_u24 v9, 13824, v2
v_lshl_add_u32 v9, v1, 4, v9
v_lshl_add_u32 v10, v0, 3, v3
s_lshl_b32 s50, s64, 8
s_add_u32 s50, s50, 4096
v_mov_b32 v14, s40
v_mov_b32 v15, 0
v_cvt_pk_bf16_f32 v12, v20, v21
v_cvt_pk_bf16_f32 v13, v22, v23
s_mov_b32 exec_lo, 0x000f000f
s_mov_b32 exec_hi, 0x000f000f
ds_write_b64 v8, v[12:13]
s_mov_b64 exec, 1
ds_add_rtn_u32 v11, v3, v4 offset:56
s_waitcnt lgkmcnt(0)
v_cmp_eq_u32 vcc, 3, v11
s_mov_b64 exec, -1
s_cbranch_vccz P_41
ds_read_b64 v[12:13], v10 offset:9600
s_waitcnt lgkmcnt(0)
buffer_store_dwordx4 v[12:15], v9, s[36:39], s50 offen sc1
P_41:
s_branch W_fed
W_q:
s_cmp_lt_u32 s35, 4
s_cbranch_scc1 W_qm
s_mul_i32 s50, s34, 1344
s_add_u32 s50, s50, 151552
v_lshl_add_u32 v8, v0, 3, s50
v_lshl_add_u32 v9, v1, 3, s50
s_mul_i32 s65, s34, 13824
s_add_u32 s65, s65, 4096
s_add_u32 s68, s65, 2304
v_lshlrev_b32 v10, 4, v0
v_lshlrev_b32 v11, 4, v1
v_cmp_gt_u32 s[66:67], 16, v0
s_waitcnt vmcnt(0)
v_lshlrev_b32 v28, 16, v20
v_and_b32 v29, 0xffff0000, v20
v_lshlrev_b32 v30, 16, v21
v_and_b32 v31, 0xffff0000, v21
v_lshlrev_b32 v32, 16, v22
v_and_b32 v33, 0xffff0000, v22
v_lshlrev_b32 v34, 16, v23
v_and_b32 v35, 0xffff0000, v23
v_lshlrev_b32 v36, 16, v24
v_and_b32 v37, 0xffff0000, v24
v_lshlrev_b32 v38, 16, v25
v_and_b32 v39, 0xffff0000, v25
v_add_f32 v20, v36, v37
v_add_f32 v21, v38, v39
v_add_f32 v20, v20, v21
v_cndmask_b32 v20, 0, v20, s[66:67]
v_add_f32 v20, v20, v28
v_add_f32 v20, v20, v29
v_add_f32 v20, v20, v30
v_add_f32 v20, v20, v31
v_add_f32 v20, v20, v32
v_add_f32 v20, v20, v33
v_add_f32 v20, v20, v34
v_add_f32 v20, v20, v35
s_nop 1
v_add_f32_dpp v20, v20, v20 quad_perm:[1,0,3,2] row_mask:0xf bank_mask:0xf
s_nop 1
v_add_f32_dpp v20, v20, v20 quad_perm:[2,3,0,1] row_mask:0xf bank_mask:0xf
s_nop 1
v_add_f32_dpp v20, v20, v20 row_half_mirror row_mask:0xf bank_mask:0xf
s_nop 1
v_add_f32_dpp v20, v20, v20 row_mirror row_mask:0xf bank_mask:0xf
v_mov_b32 v21, v20
s_nop 1
v_permlane16_swap_b32 v20, v21
v_add_f32 v20, v20, v21
v_mov_b32 v21, v20
s_nop 1
v_permlane32_swap_b32 v20, v21
v_add_f32 v20, v20, v21
v_mul_f32 v20, 0x3ae38e39, v20
v_sub_f32 v40, v28, v20
v_sub_f32 v41, v29, v20
v_sub_f32 v42, v30, v20
v_sub_f32 v43, v31, v20
v_sub_f32 v44, v32, v20
v_sub_f32 v45, v33, v20
v_sub_f32 v46, v34, v20
v_sub_f32 v47, v35, v20
v_sub_f32 v48, v36, v20
v_sub_f32 v49, v37, v20
v_sub_f32 v50, v38, v20
v_sub_f32 v51, v39, v20
v_mul_f32 v21, v48, v48
v_fmac_f32 v21, v49, v49
v_fmac_f32 v21, v50, v50
v_fmac_f32 v21, v51, v51
v_cndmask_b32 v21, 0, v21, s[66:67]
v_fmac_f32 v21, v40, v40
v_fmac_f32 v21, v41, v41
v_fmac_f32 v21, v42, v42
v_fmac_f32 v21, v43, v43
v_fmac_f32 v21, v44, v44
v_fmac_f32 v21, v45, v45
v_fmac_f32 v21, v46, v46
v_fmac_f32 v21, v47, v47
s_nop 1
v_add_f32_dpp v21, v21, v21 quad_perm:[1,0,3,2] row_mask:0xf bank_mask:0xf
s_nop 1
v_add_f32_dpp v21, v21, v21 quad_perm:[2,3,0,1] row_mask:0xf bank_mask:0xf
s_nop 1
v_add_f32_dpp v21, v21, v21 row_half_mirror row_mask:0xf bank_mask:0xf
s_nop 1
v_add_f32_dpp v21, v21, v21 row_mirror row_mask:0xf bank_mask:0xf
v_mov_b32 v22, v21
s_nop 1
v_permlane16_swap_b32 v21, v22
v_add_f32 v21, v21, v22
v_mov_b32 v22, v21
s_nop 1
v_permlane32_swap_b32 v21, v22
v_add_f32 v21, v21, v22
v_mul_f32 v21, 0x3ae38e39, v21
v_cvt_pk_bf16_f32 v22, v20, v21
v_lshlrev_b32 v20, 16, v22
v_and_b32 v21, 0xffff0000, v22
v_add_f32 v21, 0x3727c5ac, v21
v_cvt_pk_bf16_f32 v22, v21, v21
v_lshlrev_b32 v21, 16, v22
v_sqrt_f32 v21, v21
s_nop 0
v_cvt_pk_bf16_f32 v22, v21, v21
v_lshlrev_b32 v21, 16, v22
v_rcp_f32 v21, v21
v_sub_f32 v28, v28, v20
v_sub_f32 v29, v29, v20
v_sub_f32 v30, v30, v20
v_sub_f32 v31, v31, v20
v_sub_f32 v32, v32, v20
v_sub_f32 v33, v33, v20
v_sub_f32 v34, v34, v20
v_sub_f32 v35, v35, v20
v_sub_f32 v36, v36, v20
v_sub_f32 v37, v37, v20
v_sub_f32 v38, v38, v20
v_sub_f32 v39, v39, v20
v_cvt_pk_bf16_f32 v22, v28, v29
v_lshlrev_b32 v28, 16, v22
v_and_b32 v29, 0xffff0000, v22
v_cvt_pk_bf16_f32 v22, v30, v31
v_lshlrev_b32 v30, 16, v22
v_and_b32 v31, 0xffff0000, v22
v_cvt_pk_bf16_f32 v22, v32, v33
v_lshlrev_b32 v32, 16, v22
v_and_b32 v33, 0xffff0000, v22
v_cvt_pk_bf16_f32 v22, v34, v35
v_lshlrev_b32 v34, 16, v22
v_and_b32 v35, 0xffff0000, v22
v_cvt_pk_bf16_f32 v22, v36, v37
v_lshlrev_b32 v36, 16, v22
v_and_b32 v37, 0xffff0000, v22
v_cvt_pk_bf16_f32 v22, v38, v39
v_lshlrev_b32 v38, 16, v22
v_and_b32 v39, 0xffff0000, v22
v_mul_f32 v28, v28, v21
v_mul_f32 v29, v29, v21
v_mul_f32 v30, v30, v21
v_mul_f32 v31, v31, v21
v_mul_f32 v32, v32, v21
v_mul_f32 v33, v33, v21
v_mul_f32 v34, v34, v21
v_mul_f32 v35, v35, v21
v_mul_f32 v36, v36, v21
v_mul_f32 v37, v37, v21
v_mul_f32 v38, v38, v21
v_mul_f32 v39, v39, v21
v_cvt_pk_bf16_f32 v22, v28, v29
v_lshlrev_b32 v28, 16, v22
v_and_b32 v29, 0xffff0000, v22
v_cvt_pk_bf16_f32 v22, v30, v31
v_lshlrev_b32 v30, 16, v22
v_and_b32 v31, 0xffff0000, v22
v_cvt_pk_bf16_f32 v22, v32, v33
v_lshlrev_b32 v32, 16, v22
v_and_b32 v33, 0xffff0000, v22
v_cvt_pk_bf16_f32 v22, v34, v35
v_lshlrev_b32 v34, 16, v22
v_and_b32 v35, 0xffff0000, v22
v_cvt_pk_bf16_f32 v22, v36, v37
v_lshlrev_b32 v36, 16, v22
v_and_b32 v37, 0xffff0000, v22
v_cvt_pk_bf16_f32 v22, v38, v39
v_lshlrev_b32 v38, 16, v22
v_and_b32 v39, 0xffff0000, v22
s_cmp_ge_i32 s83, 18
s_cbranch_scc1 D_43
W_42:
ds_read_b32 v5, v3 offset:0
s_waitcnt lgkmcnt(0)
v_readfirstlane_b32 s83, v5
s_cmp_ge_i32 s83, 18
s_cbranch_scc1 D_43
s_sub_u32 s41, s41, 1
s_cbranch_scc1 L_bail
s_sleep 1
s_branch W_42
D_43:
s_mov_b32 s76, 63
G_44:
s_bitcmp1_b32 s76, 0
s_cbranch_scc0 K_46
buffer_load_dwordx4 v[52:55], v10, s[36:39], s68 offen offset:0 sc1
K_46:
s_bitcmp1_b32 s76, 1
s_cbranch_scc0 K_47
buffer_load_dwordx4 v[56:59], v10, s[36:39], s68 offen offset:1024 sc1
K_47:
s_bitcmp1_b32 s76, 2
s_cbranch_scc0 K_48
buffer_load_dwordx4 v[60:63], v11, s[36:39], s68 offen offset:2048 sc1
K_48:
s_bitcmp1_b32 s76, 3
s_cbranch_scc0 K_49
buffer_load_dwordx4 v[40:43], v10, s[36:39], s65 offen offset:0 sc1
K_49:
s_bitcmp1_b32 s76, 4
s_cbranch_scc0 K_50
buffer_load_dwordx4 v[44:47], v10, s[36:39], s65 offen offset:1024 sc1
K_50:
s_bitcmp1_b32 s76, 5
s_cbranch_scc0 K_51
buffer_load_dwordx4 v[48:51], v11, s[36:39], s65 offen offset:2048 sc1
K_51:
s_sub_u32 s41, s41, 16
s_cbranch_scc1 L_bail
s_mov_b32 s76, 0
s_waitcnt vmcnt(0)
v_xor_b32 v22, s40, v54
v_bitop3_b32 v22, v22, v58, s40 bitop3:0xf6
v_bitop3_b32 v22, v22, v62, s40 bitop3:0xf6
v_bitop3_b32 v22, v22, v42, s40 bitop3:0xf6
v_bitop3_b32 v22, v22, v46, s40 bitop3:0xf6
v_bitop3_b32 v22, v22, v50, s40 bitop3:0xf6
v_cmp_ne_u32 vcc, 0, v22
s_cbranch_vccz D_45
v_cmp_ne_u32 vcc, s40, v54
s_cmp_lg_u64 vcc, 0
s_cselect_b32 s77, 1, 0
s_or_b32 s76, s76, s77
v_cmp_ne_u32 vcc, s40, v58
s_cmp_lg_u64 vcc, 0
s_cselect_b32 s77, 2, 0
s_or_b32 s76, s76, s77
v_cmp_ne_u32 vcc, s40, v62
s_cmp_lg_u64 vcc, 0
s_cselect_b32 s77, 4, 0
s_or_b32 s76, s76, s77
v_cmp_ne_u32 vcc, s40, v42
s_cmp_lg_u64 vcc, 0
s_cselect_b32 s77, 8, 0
s_or_b32 s76, s76, s77
v_cmp_ne_u32 vcc, s40, v46
s_cmp_lg_u64 vcc, 0
s_cselect_b32 s77, 16, 0
s_or_b32 s76, s76, s77
v_cmp_ne_u32 vcc, s40, v50
s_cmp_lg_u64 vcc, 0
s_cselect_b32 s77, 32, 0
s_or_b32 s76, s76, s77
s_branch G_44
D_45:
v_mov_b32 v26, 1.0
v_mov_b32 v27, 1.0
v_lshlrev_b32 v64, 16, v52
v_and_b32 v65, 0xffff0000, v52
v_pk_add_f32 v[64:65], v[64:65], v[26:27]
v_cvt_pk_bf16_f32 v22, v64, v65
v_lshlrev_b32 v64, 16, v22
v_and_b32 v65, 0xffff0000, v22
v_pk_mul_f32 v[64:65], v[64:65], v[28:29]
v_cvt_pk_bf16_f32 v22, v64, v65
v_lshlrev_b32 v64, 16, v22
v_and_b32 v65, 0xffff0000, v22
v_lshlrev_b32 v66, 16, v40
v_and_b32 v67, 0xffff0000, v40
v_pk_add_f32 v[64:65], v[64:65], v[66:67]
v_cvt_pk_bf16_f32 v72, v64, v65
v_lshlrev_b32 v68, 16, v53
v_and_b32 v69, 0xffff0000, v53
v_pk_add_f32 v[68:69], v[68:69], v[26:27]
v_cvt_pk_bf16_f32 v22, v68, v69
v_lshlrev_b32 v68, 16, v22
v_and_b32 v69, 0xffff0000, v22
v_pk_mul_f32 v[68:69], v[68:69], v[30:31]
v_cvt_pk_bf16_f32 v22, v68, v69
v_lshlrev_b32 v68, 16, v22
v_and_b32 v69, 0xffff0000, v22
v_lshlrev_b32 v70, 16, v41
v_and_b32 v71, 0xffff0000, v41
v_pk_add_f32 v[68:69], v[68:69], v[70:71]
v_cvt_pk_bf16_f32 v73, v68, v69
ds_write_b64 v8, v[72:73] offset:0
v_lshlrev_b32 v64, 16, v56
v_and_b32 v65, 0xffff0000, v56
v_pk_add_f32 v[64:65], v[64:65], v[26:27]
v_cvt_pk_bf16_f32 v22, v64, v65
v_lshlrev_b32 v64, 16, v22
v_and_b32 v65, 0xffff0000, v22
v_pk_mul_f32 v[64:65], v[64:65], v[32:33]
v_cvt_pk_bf16_f32 v22, v64, v65
v_lshlrev_b32 v64, 16, v22
v_and_b32 v65, 0xffff0000, v22
v_lshlrev_b32 v66, 16, v44
v_and_b32 v67, 0xffff0000, v44
v_pk_add_f32 v[64:65], v[64:65], v[66:67]
v_cvt_pk_bf16_f32 v74, v64, v65
v_lshlrev_b32 v68, 16, v57
v_and_b32 v69, 0xffff0000, v57
v_pk_add_f32 v[68:69], v[68:69], v[26:27]
v_cvt_pk_bf16_f32 v22, v68, v69
v_lshlrev_b32 v68, 16, v22
v_and_b32 v69, 0xffff0000, v22
v_pk_mul_f32 v[68:69], v[68:69], v[34:35]
v_cvt_pk_bf16_f32 v22, v68, v69
v_lshlrev_b32 v68, 16, v22
v_and_b32 v69, 0xffff0000, v22
v_lshlrev_b32 v70, 16, v45
v_and_b32 v71, 0xffff0000, v45
v_pk_add_f32 v[68:69], v[68:69], v[70:71]
v_cvt_pk_bf16_f32 v75, v68, v69
ds_write_b64 v8, v[74:75] offset:512
v_lshlrev_b32 v64, 16, v60
v_and_b32 v65, 0xffff0000, v60
v_pk_add_f32 v[64:65], v[64:65], v[26:27]
v_cvt_pk_bf16_f32 v22, v64, v65
v_lshlrev_b32 v64, 16, v22
v_and_b32 v65, 0xffff0000, v22
v_pk_mul_f32 v[64:65], v[64:65], v[36:37]
v_cvt_pk_bf16_f32 v22, v64, v65
v_lshlrev_b32 v64, 16, v22
v_and_b32 v65, 0xffff0000, v22
v_lshlrev_b32 v66, 16, v48
v_and_b32 v67, 0xffff0000, v48
v_pk_add_f32 v[64:65], v[64:65], v[66:67]
v_cvt_pk_bf16_f32 v76, v64, v65
v_lshlrev_b32 v68, 16, v61
v_and_b32 v69, 0xffff0000, v61
v_pk_add_f32 v[68:69], v[68:69], v[26:27]
v_cvt_pk_bf16_f32 v22, v68, v69
v_lshlrev_b32 v68, 16, v22
v_and_b32 v69, 0xffff0000, v22
v_pk_mul_f32 v[68:69], v[68:69], v[38:39]
v_cvt_pk_bf16_f32 v22, v68, v69
v_lshlrev_b32 v68, 16, v22
v_and_b32 v69, 0xffff0000, v22
v_lshlrev_b32 v70, 16, v49
v_and_b32 v71, 0xffff0000, v49
v_pk_add_f32 v[68:69], v[68:69], v[70:71]
v_cvt_pk_bf16_f32 v77, v68, v69
ds_write_b64 v9, v[76:77] offset:1024
s_mov_b64 exec, 1
ds_add_u32 v3, v4 offset:28
s_mov_b64 exec, -1
s_branch W_post
W_qm:
s_lshl_b32 s64, s32, 3
s_add_u32 s64, s64, s33
s_sub_u32 s64, s64, 6
v_lshrrev_b32 v6, 3, v1
v_and_b32 v7, 1, v2
v_lshl_or_b32 v6, v7, 1, v6
v_xor_b32 v6, s34, v6
v_lshlrev_b32 v6, 5, v6
v_lshrrev_b32 v7, 2, v1
v_lshl_add_u32 v7, v2, 3, v7
v_lshl_add_u32 v6, v7, 7, v6
v_and_b32 v7, 3, v1
v_lshl_add_u32 v6, v7, 3, v6
v_add_u32 v16, 73728, v6
v_add_u32 v17, 36864, v16
v_and_b32 v6, 3, v1
v_mul_u32_u24 v6, 1344, v6
v_lshl_add_u32 v6, v2, 4, v6
v_add_u32 v18, 151552, v6
s_cmp_ge_i32 s83, 6
s_cbranch_scc1 D_53
W_52:
ds_read_b32 v5, v3 offset:0
s_waitcnt lgkmcnt(0)
v_readfirstlane_b32 s83, v5
s_cmp_ge_i32 s83, 6
s_cbranch_scc1 D_53
s_sub_u32 s41, s41, 1
s_cbranch_scc1 L_bail
s_sleep 1
s_branch W_52
D_53:
ds_read_b64_tr_b16 v[92:93], v16 offset:0
ds_read_b64_tr_b16 v[94:95], v16 offset:512
ds_read_b64_tr_b16 v[96:97], v16 offset:4096
ds_read_b64_tr_b16 v[98:99], v16 offset:4608
ds_read_b64_tr_b16 v[100:101], v16 offset:8192
ds_read_b64_tr_b16 v[102:103], v16 offset:8704
ds_read_b64_tr_b16 v[104:105], v16 offset:12288
ds_read_b64_tr_b16 v[106:107], v16 offset:12800
ds_read_b64_tr_b16 v[108:109], v16 offset:16384
ds_read_b64_tr_b16 v[110:111], v16 offset:16896
ds_read_b64_tr_b16 v[112:113], v16 offset:20480
ds_read_b64_tr_b16 v[114:115], v16 offset:20992
s_cmp_ge_i32 s83, 12
s_cbranch_scc1 D_55
W_54:
ds_read_b32 v5, v3 offset:0
s_waitcnt lgkmcnt(0)
v_readfirstlane_b32 s83, v5
s_cmp_ge_i32 s83, 12
s_cbranch_scc1 D_55
s_sub_u32 s41, s41, 1
s_cbranch_scc1 L_bail
s_sleep 1
s_branch W_54
D_55:
ds_read_b64_tr_b16 v[116:117], v16 offset:24576
ds_read_b64_tr_b16 v[118:119], v16 offset:25088
ds_read_b64_tr_b16 v[120:121], v16 offset:28672
ds_read_b64_tr_b16 v[122:123], v16 offset:29184
ds_read_b64_tr_b16 v[124:125], v16 offset:32768
ds_read_b64_tr_b16 v[126:127], v16 offset:33280
ds_read_b64_tr_b16 v[128:129], v17 offset:0
ds_read_b64_tr_b16 v[130:131], v17 offset:512
ds_read_b64_tr_b16 v[132:133], v17 offset:4096
ds_read_b64_tr_b16 v[134:135], v17 offset:4608
ds_read_b64_tr_b16 v[136:137], v17 offset:8192
ds_read_b64_tr_b16 v[138:139], v17 offset:8704
s_cmp_ge_i32 s83, 18
s_cbranch_scc1 D_57
W_56:
ds_read_b32 v5, v3 offset:0
s_waitcnt lgkmcnt(0)
v_readfirstlane_b32 s83, v5
s_cmp_ge_i32 s83, 18
s_cbranch_scc1 D_57
s_sub_u32 s41, s41, 1
s_cbranch_scc1 L_bail
s_sleep 1
s_branch W_56
D_57:
ds_read_b64_tr_b16 v[140:141], v17 offset:12288
ds_read_b64_tr_b16 v[142:143], v17 offset:12800
ds_read_b64_tr_b16 v[144:145], v17 offset:16384
ds_read_b64_tr_b16 v[146:147], v17 offset:16896
ds_read_b64_tr_b16 v[148:149], v17 offset:20480
ds_read_b64_tr_b16 v[150:151], v17 offset:20992
ds_read_b64_tr_b16 v[152:153], v17 offset:24576
ds_read_b64_tr_b16 v[154:155], v17 offset:25088
ds_read_b64_tr_b16 v[156:157], v17 offset:28672
ds_read_b64_tr_b16 v[158:159], v17 offset:29184
ds_read_b64_tr_b16 v[160:161], v17 offset:32768
ds_read_b64_tr_b16 v[162:163], v17 offset:33280
s_mov_b64 exec, 1
ds_add_u32 v3, v4 offset:4
s_mov_b64 exec, -1
W_58:
ds_read_b32 v5, v3 offset:28
s_waitcnt lgkmcnt(0)
v_cmp_le_i32 vcc, 4, v5
s_cbranch_vccnz D_59
s_sub_u32 s41, s41, 1
s_cbranch_scc1 L_bail
s_branch W_58
D_59:
ds_read_b128 v[28:31], v18 offset:0
ds_read_b128 v[32:35], v18 offset:64
ds_read_b128 v[36:39], v18 offset:128
ds_read_b128 v[40:43], v18 offset:192
ds_read_b128 v[44:47], v18 offset:256
ds_read_b128 v[48:51], v18 offset:320
ds_read_b128 v[52:55], v18 offset:384
ds_read_b128 v[56:59], v18 offset:448
ds_read_b128 v[60:63], v18 offset:512
s_waitcnt lgkmcnt(8)
v_mfma_f32_16x16x32_bf16 v[20:23], v[92:95], v[28:31], 0
ds_read_b128 v[28:31], v18 offset:576
s_waitcnt lgkmcnt(8)
v_mfma_f32_16x16x32_bf16 v[20:23], v[96:99], v[32:35], v[20:23]
ds_read_b128 v[32:35], v18 offset:640
s_waitcnt lgkmcnt(8)
v_mfma_f32_16x16x32_bf16 v[20:23], v[100:103], v[36:39], v[20:23]
ds_read_b128 v[36:39], v18 offset:704
s_waitcnt lgkmcnt(8)
v_mfma_f32_16x16x32_bf16 v[20:23], v[104:107], v[40:43], v[20:23]
ds_read_b128 v[40:43], v18 offset:768
s_waitcnt lgkmcnt(8)
v_mfma_f32_16x16x32_bf16 v[20:23], v[108:111], v[44:47], v[20:23]
ds_read_b128 v[44:47], v18 offset:832
s_waitcnt lgkmcnt(8)
v_mfma_f32_16x16x32_bf16 v[20:23], v[112:115], v[48:51], v[20:23]
ds_read_b128 v[48:51], v18 offset:896
s_waitcnt lgkmcnt(8)
v_mfma_f32_16x16x32_bf16 v[20:23], v[116:119], v[52:55], v[20:23]
ds_read_b128 v[52:55], v18 offset:960
s_waitcnt lgkmcnt(8)
v_mfma_f32_16x16x32_bf16 v[20:23], v[120:123], v[56:59], v[20:23]
ds_read_b128 v[56:59], v18 offset:1024
s_waitcnt lgkmcnt(8)
v_mfma_f32_16x16x32_bf16 v[20:23], v[124:127], v[60:63], v[20:23]
ds_read_b128 v[60:63], v18 offset:1088
s_waitcnt lgkmcnt(8)
v_mfma_f32_16x16x32_bf16 v[20:23], v[128:131], v[28:31], v[20:23]
s_waitcnt lgkmcnt(7)
v_mfma_f32_16x16x32_bf16 v[20:23], v[132:135], v[32:35], v[20:23]
s_waitcnt lgkmcnt(6)
v_mfma_f32_16x16x32_bf16 v[20:23], v[136:139], v[36:39], v[20:23]
s_waitcnt lgkmcnt(5)
v_mfma_f32_16x16x32_bf16 v[20:23], v[140:143], v[40:43], v[20:23]
s_waitcnt lgkmcnt(4)
v_mfma_f32_16x16x32_bf16 v[20:23], v[144:147], v[44:47], v[20:23]
s_waitcnt lgkmcnt(3)
v_mfma_f32_16x16x32_bf16 v[20:23], v[148:151], v[48:51], v[20:23]
s_waitcnt lgkmcnt(2)
v_mfma_f32_16x16x32_bf16 v[20:23], v[152:155], v[52:55], v[20:23]
s_waitcnt lgkmcnt(1)
v_mfma_f32_16x16x32_bf16 v[20:23], v[156:159], v[56:59], v[20:23]
s_waitcnt lgkmcnt(0)
v_mfma_f32_16x16x32_bf16 v[20:23], v[160:163], v[60:63], v[20:23]
s_lshl_b32 s50, s34, 5
s_add_u32 s50, s50, 157056
v_lshlrev_b32 v8, 7, v1
v_lshl_add_u32 v8, v2, 3, v8
v_add_u32 v8, s50, v8
v_mul_u32_u24 v9, 16384, v2
v_lshl_add_u32 v9, v1, 4, v9
v_lshl_add_u32 v10, v0, 3, v3
s_lshl_b32 s50, s64, 8
s_add_u32 s50, s50, 65536
v_mov_b32 v14, s40
v_mov_b32 v15, 0
v_cvt_pk_bf16_f32 v12, v20, v21
v_cvt_pk_bf16_f32 v13, v22, v23
s_mov_b32 exec_lo, 0x000f000f
s_mov_b32 exec_hi, 0x000f000f
ds_write_b64 v8, v[12:13]
s_mov_b64 exec, 1
ds_add_rtn_u32 v11, v3, v4 offset:56
s_waitcnt lgkmcnt(0)
v_cmp_eq_u32 vcc, 3, v11
s_mov_b64 exec, -1
s_cbranch_vccz P_60
ds_read_b64 v[12:13], v10 offset:9600
s_add_u32 s51, s50, 2818048
s_waitcnt lgkmcnt(0)
buffer_store_dwordx4 v[12:15], v9, s[36:39], s51 offen
buffer_store_dwordx4 v[12:15], v9, s[36:39], s50 offen sc1
P_60:
W_fed:
s_cmp_ge_u32 s35, 4
s_cbranch_scc1 W_post
s_mov_b64 exec, 1
ds_add_u32 v3, v4 offset:76
s_mov_b64 exec, -1
W_post:
s_cmp_lt_u32 s33, 6
s_cbranch_scc1 W_mlp
s_cmp_ge_u32 s33, 13
s_cbranch_scc1 W_mlp
s_cmp_eq_u32 s33, 12
s_cbranch_scc1 W_gb
s_lshr_b32 s78, s35, 2
s_sub_u32 s79, s33, 6
s_and_b32 s64, s79, 1
s_lshl_b32 s50, s32, 1
s_add_u32 s64, s64, s50
s_lshr_b32 s65, s79, 1
s_lshl_b32 s67, s64, 13
s_lshl_b32 s50, s78, 12
s_add_u32 s67, s67, s50
s_lshl_b32 s50, s34, 10
s_add_u32 s67, s67, s50
s_add_u32 s67, s67, 131072
v_lshlrev_b32 v21, 4, v0
v_lshrrev_b32 v6, 5, v0
v_and_b32 v7, 31, v0
s_mul_i32 s50, s34, 576
s_lshl_b32 s51, s78, 8
s_add_u32 s50, s50, s51
s_add_u32 s50, s50, 148736
v_lshlrev_b32 v22, 3, v7
v_lshl_add_u32 v22, v6, 2, v22
v_add_u32 v22, s50, v22
s_cmp_ge_u32 s35, 4
s_cbranch_scc1 W_wo1
s_mul_i32 s50, s34, 3
s_add_u32 s50, s50, 0
s_and_b32 s51, s50, 3
s_lshr_b32 s50, s50, 2
s_mul_i32 s50, s50, 4096
s_add_u32 s50, s50, 0
v_lshrrev_b32 v6, 3, v1
v_and_b32 v7, 1, v2
v_lshl_or_b32 v6, v7, 1, v6
v_xor_b32 v6, s51, v6
v_lshlrev_b32 v6, 5, v6
v_lshrrev_b32 v7, 2, v1
v_lshl_add_u32 v7, v2, 3, v7
v_lshl_add_u32 v6, v7, 7, v6
v_and_b32 v7, 3, v1
v_lshl_add_u32 v6, v7, 3, v6
v_add_u32 v16, s50, v6
s_mul_i32 s50, s34, 3
s_add_u32 s50, s50, 1
s_and_b32 s51, s50, 3
s_lshr_b32 s50, s50, 2
s_mul_i32 s50, s50, 4096
s_add_u32 s50, s50, 0
v_lshrrev_b32 v6, 3, v1
v_and_b32 v7, 1, v2
v_lshl_or_b32 v6, v7, 1, v6
v_xor_b32 v6, s51, v6
v_lshlrev_b32 v6, 5, v6
v_lshrrev_b32 v7, 2, v1
v_lshl_add_u32 v7, v2, 3, v7
v_lshl_add_u32 v6, v7, 7, v6
v_and_b32 v7, 3, v1
v_lshl_add_u32 v6, v7, 3, v6
v_add_u32 v17, s50, v6
s_mul_i32 s50, s34, 3
s_add_u32 s50, s50, 2
s_and_b32 s51, s50, 3
s_lshr_b32 s50, s50, 2
s_mul_i32 s50, s50, 4096
s_add_u32 s50, s50, 0
v_lshrrev_b32 v6, 3, v1
v_and_b32 v7, 1, v2
v_lshl_or_b32 v6, v7, 1, v6
v_xor_b32 v6, s51, v6
v_lshlrev_b32 v6, 5, v6
v_lshrrev_b32 v7, 2, v1
v_lshl_add_u32 v7, v2, 3, v7
v_lshl_add_u32 v6, v7, 7, v6
v_and_b32 v7, 3, v1
v_lshl_add_u32 v6, v7, 3, v6
v_add_u32 v18, s50, v6
v_add_u32 v12, 49152, v16
v_add_u32 v13, 49152, v17
v_add_u32 v14, 49152, v18
v_and_b32 v6, 3, v1
v_mul_u32_u24 v6, 576, v6
v_lshl_add_u32 v6, v2, 4, v6
v_add_u32 v19, 148736, v6
v_and_b32 v6, 3, v1
v_mul_u32_u24 v6, 24, v6
v_lshrrev_b32 v7, 1, v2
s_lshl_b32 s50, s34, 1
v_add3_u32 v6, v6, v7, s50
v_mul_u32_u24 v6, 2048, v6
v_and_b32 v7, 1, v2
v_lshlrev_b32 v7, 6, v7
v_lshrrev_b32 v20, 2, v1
v_lshl_add_u32 v7, v20, 4, v7
v_add_u32 v20, v6, v7
s_mov_b32 s70, 0x00f000f0
s_mov_b32 s71, 0x00f000f0
s_mov_b32 s72, 0x0f000f00
s_mov_b32 s73, 0x0f000f00
s_mov_b32 s74, 0xf000f000
s_mov_b32 s75, 0xf000f000
s_lshl_b32 s66, s65, 14
s_lshl_b32 s50, s64, 7
s_add_u32 s66, s66, s50
s_add_u32 s66, s66, 393216
v_mov_b32 v27, s40
s_cmp_ge_i32 s83, 30
s_cbranch_scc1 D_62
W_61:
ds_read_b32 v5, v3 offset:0
s_waitcnt lgkmcnt(0)
v_readfirstlane_b32 s83, v5
s_cmp_ge_i32 s83, 30
s_cbranch_scc1 D_62
s_sub_u32 s41, s41, 1
s_cbranch_scc1 L_bail
s_sleep 1
s_branch W_61
D_62:
ds_read_b64_tr_b16 v[68:69], v16 offset:0
ds_read_b64_tr_b16 v[70:71], v16 offset:512
ds_read_b64_tr_b16 v[72:73], v17 offset:0
ds_read_b64_tr_b16 v[74:75], v17 offset:512
ds_read_b64_tr_b16 v[76:77], v18 offset:0
ds_read_b64_tr_b16 v[78:79], v18 offset:512
ds_read_b64_tr_b16 v[80:81], v16 offset:12288
ds_read_b64_tr_b16 v[82:83], v16 offset:12800
ds_read_b64_tr_b16 v[84:85], v17 offset:12288
ds_read_b64_tr_b16 v[86:87], v17 offset:12800
ds_read_b64_tr_b16 v[88:89], v18 offset:12288
ds_read_b64_tr_b16 v[90:91], v18 offset:12800
ds_read_b64_tr_b16 v[92:93], v16 offset:24576
ds_read_b64_tr_b16 v[94:95], v16 offset:25088
ds_read_b64_tr_b16 v[96:97], v17 offset:24576
ds_read_b64_tr_b16 v[98:99], v17 offset:25088
ds_read_b64_tr_b16 v[100:101], v18 offset:24576
ds_read_b64_tr_b16 v[102:103], v18 offset:25088
ds_read_b64_tr_b16 v[104:105], v16 offset:36864
ds_read_b64_tr_b16 v[106:107], v16 offset:37376
ds_read_b64_tr_b16 v[108:109], v17 offset:36864
ds_read_b64_tr_b16 v[110:111], v17 offset:37376
ds_read_b64_tr_b16 v[112:113], v18 offset:36864
ds_read_b64_tr_b16 v[114:115], v18 offset:37376
s_cmp_ge_i32 s83, 42
s_cbranch_scc1 D_64
W_63:
ds_read_b32 v5, v3 offset:0
s_waitcnt lgkmcnt(0)
v_readfirstlane_b32 s83, v5
s_cmp_ge_i32 s83, 42
s_cbranch_scc1 D_64
s_sub_u32 s41, s41, 1
s_cbranch_scc1 L_bail
s_sleep 1
s_branch W_63
D_64:
ds_read_b64_tr_b16 v[116:117], v12 offset:0
ds_read_b64_tr_b16 v[118:119], v12 offset:512
ds_read_b64_tr_b16 v[120:121], v13 offset:0
ds_read_b64_tr_b16 v[122:123], v13 offset:512
ds_read_b64_tr_b16 v[124:125], v14 offset:0
ds_read_b64_tr_b16 v[126:127], v14 offset:512
ds_read_b64_tr_b16 v[128:129], v12 offset:12288
ds_read_b64_tr_b16 v[130:131], v12 offset:12800
ds_read_b64_tr_b16 v[132:133], v13 offset:12288
ds_read_b64_tr_b16 v[134:135], v13 offset:12800
ds_read_b64_tr_b16 v[136:137], v14 offset:12288
ds_read_b64_tr_b16 v[138:139], v14 offset:12800
ds_read_b64_tr_b16 v[140:141], v12 offset:24576
ds_read_b64_tr_b16 v[142:143], v12 offset:25088
ds_read_b64_tr_b16 v[144:145], v13 offset:24576
ds_read_b64_tr_b16 v[146:147], v13 offset:25088
ds_read_b64_tr_b16 v[148:149], v14 offset:24576
ds_read_b64_tr_b16 v[150:151], v14 offset:25088
ds_read_b64_tr_b16 v[152:153], v12 offset:36864
ds_read_b64_tr_b16 v[154:155], v12 offset:37376
ds_read_b64_tr_b16 v[156:157], v13 offset:36864
ds_read_b64_tr_b16 v[158:159], v13 offset:37376
ds_read_b64_tr_b16 v[160:161], v14 offset:36864
ds_read_b64_tr_b16 v[162:163], v14 offset:37376
W_wo1:
s_cmp_ge_i32 s83, 42
s_cbranch_scc1 D_66
W_65:
ds_read_b32 v5, v3 offset:0
s_waitcnt lgkmcnt(0)
v_readfirstlane_b32 s83, v5
s_cmp_ge_i32 s83, 42
s_cbranch_scc1 D_66
s_sub_u32 s41, s41, 1
s_cbranch_scc1 L_bail
s_sleep 1
s_branch W_65
D_66:
s_mov_b32 s69, 0
G_67:
s_add_u32 s69, s69, 1
s_and_b32 s68, s69, 63
s_cselect_b32 s68, 2818048, 0
s_add_u32 s68, s68, s67
buffer_load_dwordx4 v[28:31], v21, s[36:39], s68 offen offset:0 sc1
s_sub_u32 s41, s41, 16
s_cbranch_scc1 L_bail
s_waitcnt vmcnt(0)
v_xor_b32 v23, s40, v30
v_cmp_ne_u32 vcc, 0, v23
s_cbranch_vccnz G_67
v_mov_b32 v36, v31
v_mov_b32 v37, v31
v_lshlrev_b32 v40, 16, v28
v_and_b32 v41, 0xffff0000, v28
v_permlane32_swap_b32 v36, v37
v_lshlrev_b32 v42, 16, v29
v_and_b32 v43, 0xffff0000, v29
v_max_f32 v38, v36, v37
v_sub_f32 v31, v31, v38
v_sub_f32 v36, v36, v38
v_sub_f32 v37, v37, v38
v_exp_f32 v31, v31
v_exp_f32 v36, v36
v_exp_f32 v37, v37
s_nop 0
v_add_f32 v36, v36, v37
v_rcp_f32 v36, v36
s_nop 0
v_mul_f32 v31, v31, v36
v_mul_f32 v40, v40, v31
v_mul_f32 v41, v41, v31
v_mul_f32 v42, v42, v31
v_mul_f32 v43, v43, v31
s_nop 0
v_permlane32_swap_b32 v40, v42
v_permlane32_swap_b32 v41, v43
v_add_f32 v40, v40, v42
v_add_f32 v41, v41, v43
v_cvt_pk_bf16_f32 v40, v40, v41
ds_write_b32 v22, v40
s_mov_b64 exec, 1
ds_add_u32 v3, v4 offset:32
s_mov_b64 exec, -1
s_cmp_ge_u32 s35, 4
s_cbranch_scc1 L_exit
W_68:
ds_read_b32 v5, v3 offset:32
s_waitcnt lgkmcnt(0)
v_cmp_le_i32 vcc, 8, v5
s_cbranch_vccnz D_69
s_sub_u32 s41, s41, 1
s_cbranch_scc1 L_bail
s_branch W_68
D_69:
ds_read_b128 v[36:39], v19 offset:0
ds_read_b128 v[40:43], v19 offset:64
ds_read_b128 v[44:47], v19 offset:128
ds_read_b128 v[48:51], v19 offset:192
ds_read_b128 v[52:55], v19 offset:256
ds_read_b128 v[56:59], v19 offset:320
ds_read_b128 v[60:63], v19 offset:384
ds_read_b128 v[64:67], v19 offset:448
s_waitcnt lgkmcnt(7)
v_mfma_f32_16x16x32_bf16 v[8:11], v[68:71], v[36:39], 0
v_mfma_f32_16x16x32_bf16 v[28:31], v[72:75], v[36:39], 0
v_mfma_f32_16x16x32_bf16 v[32:35], v[76:79], v[36:39], 0
s_waitcnt lgkmcnt(6)
v_mfma_f32_16x16x32_bf16 v[8:11], v[80:83], v[40:43], v[8:11]
v_mfma_f32_16x16x32_bf16 v[28:31], v[84:87], v[40:43], v[28:31]
v_mfma_f32_16x16x32_bf16 v[32:35], v[88:91], v[40:43], v[32:35]
s_waitcnt lgkmcnt(5)
v_mfma_f32_16x16x32_bf16 v[8:11], v[92:95], v[44:47], v[8:11]
v_mfma_f32_16x16x32_bf16 v[28:31], v[96:99], v[44:47], v[28:31]
v_mfma_f32_16x16x32_bf16 v[32:35], v[100:103], v[44:47], v[32:35]
s_waitcnt lgkmcnt(4)
v_mfma_f32_16x16x32_bf16 v[8:11], v[104:107], v[48:51], v[8:11]
v_mfma_f32_16x16x32_bf16 v[28:31], v[108:111], v[48:51], v[28:31]
v_mfma_f32_16x16x32_bf16 v[32:35], v[112:115], v[48:51], v[32:35]
s_waitcnt lgkmcnt(3)
v_mfma_f32_16x16x32_bf16 v[8:11], v[116:119], v[52:55], v[8:11]
v_mfma_f32_16x16x32_bf16 v[28:31], v[120:123], v[52:55], v[28:31]
v_mfma_f32_16x16x32_bf16 v[32:35], v[124:127], v[52:55], v[32:35]
s_waitcnt lgkmcnt(2)
v_mfma_f32_16x16x32_bf16 v[8:11], v[128:131], v[56:59], v[8:11]
v_mfma_f32_16x16x32_bf16 v[28:31], v[132:135], v[56:59], v[28:31]
v_mfma_f32_16x16x32_bf16 v[32:35], v[136:139], v[56:59], v[32:35]
s_waitcnt lgkmcnt(1)
v_mfma_f32_16x16x32_bf16 v[8:11], v[140:143], v[60:63], v[8:11]
v_mfma_f32_16x16x32_bf16 v[28:31], v[144:147], v[60:63], v[28:31]
v_mfma_f32_16x16x32_bf16 v[32:35], v[148:151], v[60:63], v[32:35]
s_waitcnt lgkmcnt(0)
v_mfma_f32_16x16x32_bf16 v[8:11], v[152:155], v[64:67], v[8:11]
v_mfma_f32_16x16x32_bf16 v[28:31], v[156:159], v[64:67], v[28:31]
v_mfma_f32_16x16x32_bf16 v[32:35], v[160:163], v[64:67], v[32:35]
s_nop 5
v_cndmask_b32 v24, v8, v9, s[70:71]
v_cndmask_b32 v25, v28, v29, s[70:71]
v_cndmask_b32 v26, v32, v33, s[70:71]
v_cndmask_b32 v24, v24, v10, s[72:73]
v_cndmask_b32 v25, v25, v30, s[72:73]
v_cndmask_b32 v26, v26, v34, s[72:73]
v_cndmask_b32 v24, v24, v11, s[74:75]
v_cndmask_b32 v25, v25, v31, s[74:75]
v_cndmask_b32 v26, v26, v35, s[74:75]
buffer_store_dwordx4 v[24:27], v20, s[36:39], s66 offen sc1
s_cmp_lg_u32 s34, 0
s_cbranch_scc1 L_exit
s_lshl_b32 s50, s32, 12
s_lshl_b32 s51, s79, 7
s_add_u32 s50, s50, s51
s_add_u32 s50, s50, 819200
v_mov_b32 v36, s40
v_lshlrev_b32 v37, 2, v0
s_mov_b64 exec, 0xffffffff
buffer_store_dword v36, v37, s[36:39], s50 offen
s_mov_b64 exec, -1
s_branch L_exit
W_gb:
s_cmp_ge_u32 s32, 6
s_cbranch_scc1 L_exit
s_cmp_ge_u32 s35, 4
s_cbranch_scc1 L_exit
s_add_u32 s64, s32, 48
W_70:
ds_read_b32 v5, v3 offset:76
s_waitcnt lgkmcnt(0)
v_cmp_le_i32 vcc, 4, v5
s_cbranch_vccnz D_71
s_sub_u32 s41, s41, 1
s_cbranch_scc1 L_bail
s_sleep 1
s_branch W_70
D_71:
s_mul_i32 s50, s34, 1152
v_lshl_add_u32 v6, v0, 3, s50
v_lshl_add_u32 v7, v1, 3, s50
global_load_dwordx2 v[20:21], v6, s[22:23]
global_load_dwordx2 v[22:23], v6, s[22:23] offset:512
global_load_dwordx2 v[24:25], v7, s[22:23] offset:1024
s_mul_i32 s50, s34, 1344
s_add_u32 s50, s50, 151552
v_lshl_add_u32 v8, v0, 3, s50
v_lshl_add_u32 v9, v1, 3, s50
v_lshrrev_b32 v6, 3, v1
v_and_b32 v7, 1, v2
v_lshl_or_b32 v6, v7, 1, v6
v_xor_b32 v6, s34, v6
v_lshlrev_b32 v6, 5, v6
v_lshrrev_b32 v7, 2, v1
v_lshl_add_u32 v7, v2, 3, v7
v_lshl_add_u32 v6, v7, 7, v6
v_and_b32 v7, 3, v1
v_lshl_add_u32 v6, v7, 3, v6
v_add_u32 v16, 0, v6
v_add_u32 v17, 36864, v16
v_and_b32 v6, 3, v1
v_mul_u32_u24 v6, 1344, v6
v_lshl_add_u32 v6, v2, 4, v6
v_add_u32 v18, 151552, v6
s_waitcnt vmcnt(0)
v_lshlrev_b32 v28, 16, v20
v_and_b32 v29, 0xffff0000, v20
v_lshlrev_b32 v30, 16, v21
v_and_b32 v31, 0xffff0000, v21
v_lshlrev_b32 v32, 16, v22
v_and_b32 v33, 0xffff0000, v22
v_lshlrev_b32 v34, 16, v23
v_and_b32 v35, 0xffff0000, v23
v_lshlrev_b32 v36, 16, v24
v_and_b32 v37, 0xffff0000, v24
v_lshlrev_b32 v38, 16, v25
v_and_b32 v39, 0xffff0000, v25
v_mul_f32 v40, 0xbfb8aa3b, v28
v_min_f32 v40, 0x42f00000, v40
v_exp_f32 v40, v40
v_mul_f32 v41, 0xbfb8aa3b, v29
v_min_f32 v41, 0x42f00000, v41
v_exp_f32 v41, v41
v_mul_f32 v42, 0xbfb8aa3b, v30
v_min_f32 v42, 0x42f00000, v42
v_exp_f32 v42, v42
v_mul_f32 v43, 0xbfb8aa3b, v31
v_min_f32 v43, 0x42f00000, v43
v_exp_f32 v43, v43
v_mul_f32 v44, 0xbfb8aa3b, v32
v_min_f32 v44, 0x42f00000, v44
v_exp_f32 v44, v44
v_mul_f32 v45, 0xbfb8aa3b, v33
v_min_f32 v45, 0x42f00000, v45
v_exp_f32 v45, v45
v_mul_f32 v46, 0xbfb8aa3b, v34
v_min_f32 v46, 0x42f00000, v46
v_exp_f32 v46, v46
v_mul_f32 v47, 0xbfb8aa3b, v35
v_min_f32 v47, 0x42f00000, v47
v_exp_f32 v47, v47
v_mul_f32 v48, 0xbfb8aa3b, v36
v_min_f32 v48, 0x42f00000, v48
v_exp_f32 v48, v48
v_mul_f32 v49, 0xbfb8aa3b, v37
v_min_f32 v49, 0x42f00000, v49
v_exp_f32 v49, v49
v_mul_f32 v50, 0xbfb8aa3b, v38
v_min_f32 v50, 0x42f00000, v50
v_exp_f32 v50, v50
v_mul_f32 v51, 0xbfb8aa3b, v39
v_min_f32 v51, 0x42f00000, v51
v_exp_f32 v51, v51
v_add_f32 v40, 1.0, v40
v_rcp_f32 v52, v40
v_add_f32 v41, 1.0, v41
v_rcp_f32 v53, v41
v_add_f32 v42, 1.0, v42
v_rcp_f32 v54, v42
v_add_f32 v43, 1.0, v43
v_rcp_f32 v55, v43
v_add_f32 v44, 1.0, v44
v_rcp_f32 v56, v44
v_add_f32 v45, 1.0, v45
v_rcp_f32 v57, v45
v_add_f32 v46, 1.0, v46
v_rcp_f32 v58, v46
v_add_f32 v47, 1.0, v47
v_rcp_f32 v59, v47
v_add_f32 v48, 1.0, v48
v_rcp_f32 v60, v48
v_add_f32 v49, 1.0, v49
v_rcp_f32 v61, v49
v_add_f32 v50, 1.0, v50
v_rcp_f32 v62, v50
v_add_f32 v51, 1.0, v51
v_rcp_f32 v63, v51
v_mul_f32 v64, v28, v52
v_fma_f32 v40, -v64, v40, v28
v_fma_f32 v64, v40, v52, v64
v_mul_f32 v65, v29, v53
v_fma_f32 v41, -v65, v41, v29
v_fma_f32 v65, v41, v53, v65
v_mul_f32 v66, v30, v54
v_fma_f32 v42, -v66, v42, v30
v_fma_f32 v66, v42, v54, v66
v_mul_f32 v67, v31, v55
v_fma_f32 v43, -v67, v43, v31
v_fma_f32 v67, v43, v55, v67
v_mul_f32 v68, v32, v56
v_fma_f32 v44, -v68, v44, v32
v_fma_f32 v68, v44, v56, v68
v_mul_f32 v69, v33, v57
v_fma_f32 v45, -v69, v45, v33
v_fma_f32 v69, v45, v57, v69
v_mul_f32 v70, v34, v58
v_fma_f32 v46, -v70, v46, v34
v_fma_f32 v70, v46, v58, v70
v_mul_f32 v71, v35, v59
v_fma_f32 v47, -v71, v47, v35
v_fma_f32 v71, v47, v59, v71
v_mul_f32 v72, v36, v60
v_fma_f32 v48, -v72, v48, v36
v_fma_f32 v72, v48, v60, v72
v_mul_f32 v73, v37, v61
v_fma_f32 v49, -v73, v49, v37
v_fma_f32 v73, v49, v61, v73
v_mul_f32 v74, v38, v62
v_fma_f32 v50, -v74, v50, v38
v_fma_f32 v74, v50, v62, v74
v_mul_f32 v75, v39, v63
v_fma_f32 v51, -v75, v51, v39
v_fma_f32 v75, v51, v63, v75
v_cvt_pk_bf16_f32 v20, v64, v65
v_cvt_pk_bf16_f32 v21, v66, v67
v_cvt_pk_bf16_f32 v22, v68, v69
v_cvt_pk_bf16_f32 v23, v70, v71
v_cvt_pk_bf16_f32 v24, v72, v73
v_cvt_pk_bf16_f32 v25, v74, v75
ds_write_b64 v8, v[20:21]
ds_write_b64 v8, v[22:23] offset:512
ds_write_b64 v9, v[24:25] offset:1024
s_mov_b64 exec, 1
ds_add_u32 v3, v4 offset:48
s_mov_b64 exec, -1
W_72:
ds_read_b32 v5, v3 offset:48
s_waitcnt lgkmcnt(0)
v_cmp_le_i32 vcc, 4, v5
s_cbranch_vccnz D_73
s_sub_u32 s41, s41, 1
s_cbranch_scc1 L_bail
s_sleep 1
s_branch W_72
D_73:
ds_read_b128 v[32:35], v18 offset:0
ds_read_b128 v[36:39], v18 offset:64
ds_read_b128 v[40:43], v18 offset:128
ds_read_b128 v[44:47], v18 offset:192
ds_read_b128 v[48:51], v18 offset:256
ds_read_b128 v[52:55], v18 offset:320
ds_read_b128 v[56:59], v18 offset:384
ds_read_b128 v[60:63], v18 offset:448
ds_read_b128 v[64:67], v18 offset:512
ds_read_b128 v[68:71], v18 offset:576
ds_read_b128 v[72:75], v18 offset:640
ds_read_b128 v[76:79], v18 offset:704
ds_read_b128 v[80:83], v18 offset:768
ds_read_b128 v[84:87], v18 offset:832
ds_read_b128 v[88:91], v18 offset:896
ds_read_b128 v[92:95], v18 offset:960
ds_read_b128 v[96:99], v18 offset:1024
ds_read_b128 v[100:103], v18 offset:1088
W_74:
ds_read_b32 v5, v3 offset:0
s_waitcnt lgkmcnt(0)
v_cmp_le_i32 vcc, 24, v5
s_cbranch_vccnz D_75
s_sub_u32 s41, s41, 1
s_cbranch_scc1 L_bail
s_branch W_74
D_75:
ds_read_b64_tr_b16 v[104:105], v16 offset:0
ds_read_b64_tr_b16 v[106:107], v16 offset:512
ds_read_b64_tr_b16 v[108:109], v16 offset:4096
ds_read_b64_tr_b16 v[110:111], v16 offset:4608
ds_read_b64_tr_b16 v[112:113], v16 offset:8192
ds_read_b64_tr_b16 v[114:115], v16 offset:8704
ds_read_b64_tr_b16 v[116:117], v16 offset:12288
ds_read_b64_tr_b16 v[118:119], v16 offset:12800
ds_read_b64_tr_b16 v[120:121], v16 offset:16384
ds_read_b64_tr_b16 v[122:123], v16 offset:16896
ds_read_b64_tr_b16 v[124:125], v16 offset:20480
ds_read_b64_tr_b16 v[126:127], v16 offset:20992
s_waitcnt lgkmcnt(10)
v_mfma_f32_16x16x32_bf16 v[20:23], v[104:107], v[32:35], 0
s_waitcnt lgkmcnt(8)
v_mfma_f32_16x16x32_bf16 v[20:23], v[108:111], v[36:39], v[20:23]
s_waitcnt lgkmcnt(6)
v_mfma_f32_16x16x32_bf16 v[20:23], v[112:115], v[40:43], v[20:23]
s_waitcnt lgkmcnt(4)
v_mfma_f32_16x16x32_bf16 v[20:23], v[116:119], v[44:47], v[20:23]
s_waitcnt lgkmcnt(2)
v_mfma_f32_16x16x32_bf16 v[20:23], v[120:123], v[48:51], v[20:23]
s_waitcnt lgkmcnt(0)
v_mfma_f32_16x16x32_bf16 v[20:23], v[124:127], v[52:55], v[20:23]
W_76:
ds_read_b32 v5, v3 offset:0
s_waitcnt lgkmcnt(0)
v_cmp_le_i32 vcc, 30, v5
s_cbranch_vccnz D_77
s_sub_u32 s41, s41, 1
s_cbranch_scc1 L_bail
s_branch W_76
D_77:
ds_read_b64_tr_b16 v[104:105], v16 offset:24576
ds_read_b64_tr_b16 v[106:107], v16 offset:25088
ds_read_b64_tr_b16 v[108:109], v16 offset:28672
ds_read_b64_tr_b16 v[110:111], v16 offset:29184
ds_read_b64_tr_b16 v[112:113], v16 offset:32768
ds_read_b64_tr_b16 v[114:115], v16 offset:33280
ds_read_b64_tr_b16 v[116:117], v17 offset:0
ds_read_b64_tr_b16 v[118:119], v17 offset:512
ds_read_b64_tr_b16 v[120:121], v17 offset:4096
ds_read_b64_tr_b16 v[122:123], v17 offset:4608
ds_read_b64_tr_b16 v[124:125], v17 offset:8192
ds_read_b64_tr_b16 v[126:127], v17 offset:8704
s_waitcnt lgkmcnt(10)
v_mfma_f32_16x16x32_bf16 v[20:23], v[104:107], v[56:59], v[20:23]
s_waitcnt lgkmcnt(8)
v_mfma_f32_16x16x32_bf16 v[20:23], v[108:111], v[60:63], v[20:23]
s_waitcnt lgkmcnt(6)
v_mfma_f32_16x16x32_bf16 v[20:23], v[112:115], v[64:67], v[20:23]
s_waitcnt lgkmcnt(4)
v_mfma_f32_16x16x32_bf16 v[20:23], v[116:119], v[68:71], v[20:23]
s_waitcnt lgkmcnt(2)
v_mfma_f32_16x16x32_bf16 v[20:23], v[120:123], v[72:75], v[20:23]
s_waitcnt lgkmcnt(0)
v_mfma_f32_16x16x32_bf16 v[20:23], v[124:127], v[76:79], v[20:23]
W_78:
ds_read_b32 v5, v3 offset:0
s_waitcnt lgkmcnt(0)
v_cmp_le_i32 vcc, 36, v5
s_cbranch_vccnz D_79
s_sub_u32 s41, s41, 1
s_cbranch_scc1 L_bail
s_branch W_78
D_79:
ds_read_b64_tr_b16 v[104:105], v17 offset:12288
ds_read_b64_tr_b16 v[106:107], v17 offset:12800
ds_read_b64_tr_b16 v[108:109], v17 offset:16384
ds_read_b64_tr_b16 v[110:111], v17 offset:16896
ds_read_b64_tr_b16 v[112:113], v17 offset:20480
ds_read_b64_tr_b16 v[114:115], v17 offset:20992
ds_read_b64_tr_b16 v[116:117], v17 offset:24576
ds_read_b64_tr_b16 v[118:119], v17 offset:25088
ds_read_b64_tr_b16 v[120:121], v17 offset:28672
ds_read_b64_tr_b16 v[122:123], v17 offset:29184
ds_read_b64_tr_b16 v[124:125], v17 offset:32768
ds_read_b64_tr_b16 v[126:127], v17 offset:33280
s_waitcnt lgkmcnt(10)
v_mfma_f32_16x16x32_bf16 v[20:23], v[104:107], v[80:83], v[20:23]
s_waitcnt lgkmcnt(8)
v_mfma_f32_16x16x32_bf16 v[20:23], v[108:111], v[84:87], v[20:23]
s_waitcnt lgkmcnt(6)
v_mfma_f32_16x16x32_bf16 v[20:23], v[112:115], v[88:91], v[20:23]
s_waitcnt lgkmcnt(4)
v_mfma_f32_16x16x32_bf16 v[20:23], v[116:119], v[92:95], v[20:23]
s_waitcnt lgkmcnt(2)
v_mfma_f32_16x16x32_bf16 v[20:23], v[120:123], v[96:99], v[20:23]
s_waitcnt lgkmcnt(0)
v_mfma_f32_16x16x32_bf16 v[20:23], v[124:127], v[100:103], v[20:23]
s_lshl_b32 s50, s34, 5
s_add_u32 s50, s50, 157056
v_lshlrev_b32 v8, 7, v1
v_lshl_add_u32 v8, v2, 3, v8
v_add_u32 v8, s50, v8
v_mul_u32_u24 v9, 13824, v2
v_lshl_add_u32 v9, v1, 4, v9
v_lshl_add_u32 v10, v0, 3, v3
s_lshl_b32 s50, s64, 8
s_add_u32 s50, s50, 4096
v_mov_b32 v14, s40
v_mov_b32 v15, 0
v_cvt_pk_bf16_f32 v12, v20, v21
v_cvt_pk_bf16_f32 v13, v22, v23
s_mov_b32 exec_lo, 0x000f000f
s_mov_b32 exec_hi, 0x000f000f
ds_write_b64 v8, v[12:13]
s_mov_b64 exec, 1
ds_add_rtn_u32 v11, v3, v4 offset:60
s_waitcnt lgkmcnt(0)
v_cmp_eq_u32 vcc, 3, v11
s_mov_b64 exec, -1
s_cbranch_vccz P_80
ds_read_b64 v[12:13], v10 offset:9600
s_waitcnt lgkmcnt(0)
buffer_store_dwordx4 v[12:15], v9, s[36:39], s50 offen sc1
P_80:
s_branch L_exit
W_mlp:
s_add_u32 s79, s33, 1
s_cmp_eq_u32 s33, 13
s_cselect_b32 s79, 7, s79
s_cmp_eq_u32 s33, 14
s_cselect_b32 s79, 0, s79
s_cmp_eq_u32 s33, 15
s_cselect_b32 s79, 8, s79
s_sub_u32 s50, 3, s32
s_and_b32 s50, s50, 7
s_add_u32 s50, s50, s79
s_cmp_ge_u32 s50, 9
s_cselect_b32 s51, 9, 0
s_sub_u32 s50, s50, s51
s_mul_i32 s64, s32, 9
s_add_u32 s64, s64, s50
v_lshrrev_b32 v6, 3, v1
v_and_b32 v7, 1, v2
v_lshl_or_b32 v6, v7, 1, v6
v_and_b32 v8, 2, v1
v_lshl_or_b32 v6, v8, 1, v6
v_xor_b32 v6, s35, v6
v_lshlrev_b32 v6, 4, v6
v_lshl_add_u32 v6, v7, 10, v6
v_lshl_add_u32 v6, v8, 10, v6
v_lshrrev_b32 v7, 1, v2
v_lshl_add_u32 v6, v7, 12, v6
v_lshrrev_b32 v7, 2, v1
v_lshl_add_u32 v6, v7, 7, v6
v_and_b32 v7, 1, v1
v_lshl_add_u32 v13, v7, 3, v6
v_add_u32 v14, 0x10000, v13
v_add_u32 v15, 0x20000, v13
v_and_b32 v6, 3, v1
v_mul_u32_u24 v6, 1344, v6
v_lshl_add_u32 v6, v2, 4, v6
v_add_u32 v19, 151552, v6
v_and_b32 v6, 3, v1
v_mul_u32_u24 v6, 192, v6
v_and_b32 v7, 1, v2
v_lshl_add_u32 v6, v7, 3, v6
v_lshrrev_b32 v7, 1, v2
v_lshl_add_u32 v6, v7, 2, v6
s_lshl_b32 s50, s35, 4
s_add_u32 s50, s50, 147968
v_add_u32 v11, s50, v6
s_cmp_ge_i32 s83, 36
s_cbranch_scc1 D_82
W_81:
ds_read_b32 v5, v3 offset:0
s_waitcnt lgkmcnt(0)
v_readfirstlane_b32 s83, v5
s_cmp_ge_i32 s83, 36
s_cbranch_scc1 D_82
s_sub_u32 s41, s41, 1
s_cbranch_scc1 L_bail
s_sleep 1
s_branch W_81
D_82:
ds_read_b64_tr_b16 v[92:93], v13 offset:0
ds_read_b64_tr_b16 v[94:95], v13 offset:512
ds_read_b64_tr_b16 v[96:97], v13 offset:8192
ds_read_b64_tr_b16 v[98:99], v13 offset:8704
ds_read_b64_tr_b16 v[100:101], v13 offset:16384
ds_read_b64_tr_b16 v[102:103], v13 offset:16896
ds_read_b64_tr_b16 v[104:105], v13 offset:24576
ds_read_b64_tr_b16 v[106:107], v13 offset:25088
ds_read_b64_tr_b16 v[108:109], v13 offset:32768
ds_read_b64_tr_b16 v[110:111], v13 offset:33280
ds_read_b64_tr_b16 v[112:113], v13 offset:40960
ds_read_b64_tr_b16 v[114:115], v13 offset:41472
ds_read_b64_tr_b16 v[116:117], v13 offset:49152
ds_read_b64_tr_b16 v[118:119], v13 offset:49664
ds_read_b64_tr_b16 v[120:121], v13 offset:57344
ds_read_b64_tr_b16 v[122:123], v13 offset:57856
ds_read_b64_tr_b16 v[124:125], v14 offset:0
ds_read_b64_tr_b16 v[126:127], v14 offset:512
s_mov_b64 exec, 1
ds_add_u32 v3, v4 offset:80
s_mov_b64 exec, -1
s_cmp_ge_u32 s35, 4
s_cbranch_scc1 W_ln
s_mul_i32 s50, s34, 3
s_add_u32 s50, s50, 0
s_and_b32 s51, s50, 3
s_lshr_b32 s50, s50, 2
s_mul_i32 s50, s50, 4096
s_add_u32 s50, s50, 0
v_lshrrev_b32 v6, 3, v1
v_and_b32 v7, 1, v2
v_lshl_or_b32 v6, v7, 1, v6
v_xor_b32 v6, s51, v6
v_lshlrev_b32 v6, 5, v6
v_lshrrev_b32 v7, 2, v1
v_lshl_add_u32 v7, v2, 3, v7
v_lshl_add_u32 v6, v7, 7, v6
v_and_b32 v7, 3, v1
v_lshl_add_u32 v6, v7, 3, v6
v_add_u32 v16, s50, v6
s_mul_i32 s50, s34, 3
s_add_u32 s50, s50, 1
s_and_b32 s51, s50, 3
s_lshr_b32 s50, s50, 2
s_mul_i32 s50, s50, 4096
s_add_u32 s50, s50, 0
v_lshrrev_b32 v6, 3, v1
v_and_b32 v7, 1, v2
v_lshl_or_b32 v6, v7, 1, v6
v_xor_b32 v6, s51, v6
v_lshlrev_b32 v6, 5, v6
v_lshrrev_b32 v7, 2, v1
v_lshl_add_u32 v7, v2, 3, v7
v_lshl_add_u32 v6, v7, 7, v6
v_and_b32 v7, 3, v1
v_lshl_add_u32 v6, v7, 3, v6
v_add_u32 v17, s50, v6
s_mul_i32 s50, s34, 3
s_add_u32 s50, s50, 2
s_and_b32 s51, s50, 3
s_lshr_b32 s50, s50, 2
s_mul_i32 s50, s50, 4096
s_add_u32 s50, s50, 0
v_lshrrev_b32 v6, 3, v1
v_and_b32 v7, 1, v2
v_lshl_or_b32 v6, v7, 1, v6
v_xor_b32 v6, s51, v6
v_lshlrev_b32 v6, 5, v6
v_lshrrev_b32 v7, 2, v1
v_lshl_add_u32 v7, v2, 3, v7
v_lshl_add_u32 v6, v7, 7, v6
v_and_b32 v7, 3, v1
v_lshl_add_u32 v6, v7, 3, v6
v_add_u32 v18, s50, v6
v_and_b32 v6, 3, v1
v_mul_u32_u24 v6, 192, v6
v_lshl_add_u32 v6, v2, 4, v6
v_add_u32 v10, 147968, v6
v_and_b32 v6, 3, v1
v_mul_u32_u24 v6, 24, v6
v_lshrrev_b32 v7, 1, v2
s_lshl_b32 s50, s34, 1
v_add3_u32 v6, v6, v7, s50
v_mul_u32_u24 v6, 9216, v6
v_and_b32 v7, 1, v2
v_lshlrev_b32 v7, 6, v7
v_lshrrev_b32 v12, 2, v1
v_lshl_add_u32 v7, v12, 4, v7
v_add_u32 v12, v6, v7
s_mov_b32 s70, 0x00f000f0
s_mov_b32 s71, 0x00f000f0
s_mov_b32 s72, 0x0f000f00
s_mov_b32 s73, 0x0f000f00
s_mov_b32 s74, 0xf000f000
s_mov_b32 s75, 0xf000f000
s_lshl_b32 s66, s64, 7
s_add_u32 s66, s66, 1048576
s_add_u32 s67, s66, 73728
s_add_u32 s68, s67, 73728
v_mov_b32 v67, s40
v_mov_b32 v71, s40
v_mov_b32 v75, s40
s_cmp_ge_i32 s83, 54
s_cbranch_scc1 D_84
W_83:
ds_read_b32 v5, v3 offset:0
s_waitcnt lgkmcnt(0)
v_readfirstlane_b32 s83, v5
s_cmp_ge_i32 s83, 54
s_cbranch_scc1 D_84
s_sub_u32 s41, s41, 1
s_cbranch_scc1 L_bail
s_sleep 1
s_branch W_83
D_84:
ds_read_b64_tr_b16 v[128:129], v14 offset:8192
ds_read_b64_tr_b16 v[130:131], v14 offset:8704
ds_read_b64_tr_b16 v[132:133], v14 offset:16384
ds_read_b64_tr_b16 v[134:135], v14 offset:16896
ds_read_b64_tr_b16 v[136:137], v14 offset:24576
ds_read_b64_tr_b16 v[138:139], v14 offset:25088
ds_read_b64_tr_b16 v[140:141], v14 offset:32768
ds_read_b64_tr_b16 v[142:143], v14 offset:33280
ds_read_b64_tr_b16 v[144:145], v14 offset:40960
ds_read_b64_tr_b16 v[146:147], v14 offset:41472
ds_read_b64_tr_b16 v[148:149], v14 offset:49152
ds_read_b64_tr_b16 v[150:151], v14 offset:49664
ds_read_b64_tr_b16 v[152:153], v14 offset:57344
ds_read_b64_tr_b16 v[154:155], v14 offset:57856
ds_read_b64_tr_b16 v[156:157], v15 offset:0
ds_read_b64_tr_b16 v[158:159], v15 offset:512
ds_read_b64_tr_b16 v[160:161], v15 offset:8192
ds_read_b64_tr_b16 v[162:163], v15 offset:8704
s_branch W_gu
W_ln:
s_mul_i32 s60, s34, 13824
s_add_u32 s60, s60, 11008
s_add_u32 s61, s60, 2304
v_lshlrev_b32 v16, 4, v0
v_lshlrev_b32 v17, 4, v1
s_mul_i32 s50, s34, 1152
s_add_u32 s50, s50, 157696
v_lshl_add_u32 v8, v0, 3, s50
v_lshl_add_u32 v9, v1, 3, s50
v_mul_u32_u24 v6, 48, v2
v_add_u32 v6, v6, v1
v_lshl_add_u32 v10, v6, 1, s50
s_mul_i32 s50, s34, 1344
s_add_u32 s50, s50, 151552
v_lshl_add_u32 v12, v6, 1, s50
G_85:
buffer_load_dwordx4 v[28:31], v16, s[36:39], s60 offen offset:0 sc1
buffer_load_dwordx4 v[32:35], v16, s[36:39], s60 offen offset:1024 sc1
buffer_load_dwordx4 v[36:39], v17, s[36:39], s60 offen offset:2048 sc1
buffer_load_dwordx4 v[40:43], v16, s[36:39], s61 offen offset:0 sc1
buffer_load_dwordx4 v[44:47], v16, s[36:39], s61 offen offset:1024 sc1
buffer_load_dwordx4 v[48:51], v17, s[36:39], s61 offen offset:2048 sc1
s_sub_u32 s41, s41, 16
s_cbranch_scc1 L_bail
s_waitcnt vmcnt(5)
v_xor_b32 v22, s40, v30
s_waitcnt vmcnt(4)
v_bitop3_b32 v22, v22, v34, s40 bitop3:0xf6
s_waitcnt vmcnt(3)
v_bitop3_b32 v22, v22, v38, s40 bitop3:0xf6
s_waitcnt vmcnt(2)
v_bitop3_b32 v22, v22, v42, s40 bitop3:0xf6
s_waitcnt vmcnt(1)
v_bitop3_b32 v22, v22, v46, s40 bitop3:0xf6
s_waitcnt vmcnt(0)
v_bitop3_b32 v22, v22, v50, s40 bitop3:0xf6
v_cmp_ne_u32 vcc, 0, v22
s_cbranch_vccz D_86
s_sleep 8
s_branch G_85
D_86:
ds_write_b64 v8, v[28:29]
ds_write_b64 v8, v[32:33] offset:512
ds_write_b64 v9, v[36:37] offset:1024
ds_read_u16 v64, v10 offset:0
ds_read_u16 v65, v10 offset:32
ds_read_u16 v66, v10 offset:64
ds_read_u16 v67, v10 offset:384
ds_read_u16 v68, v10 offset:416
ds_read_u16 v69, v10 offset:448
ds_read_u16 v70, v10 offset:768
ds_read_u16 v71, v10 offset:800
ds_read_u16 v72, v10 offset:832
ds_write_b64 v8, v[40:41]
ds_write_b64 v8, v[44:45] offset:512
ds_write_b64 v9, v[48:49] offset:1024
ds_read_u16 v76, v10 offset:0
ds_read_u16 v77, v10 offset:32
ds_read_u16 v78, v10 offset:64
ds_read_u16 v79, v10 offset:384
ds_read_u16 v80, v10 offset:416
ds_read_u16 v81, v10 offset:448
ds_read_u16 v82, v10 offset:768
ds_read_u16 v83, v10 offset:800
ds_read_u16 v84, v10 offset:832
s_waitcnt lgkmcnt(0)
v_lshlrev_b32 v64, 16, v64
v_lshlrev_b32 v76, 16, v76
v_add_f32 v76, 1.0, v76
v_cvt_pk_bf16_f32 v22, v76, v76
v_lshlrev_b32 v76, 16, v22
v_lshlrev_b32 v65, 16, v65
v_lshlrev_b32 v77, 16, v77
v_add_f32 v77, 1.0, v77
v_cvt_pk_bf16_f32 v22, v77, v77
v_lshlrev_b32 v77, 16, v22
v_lshlrev_b32 v66, 16, v66
v_lshlrev_b32 v78, 16, v78
v_add_f32 v78, 1.0, v78
v_cvt_pk_bf16_f32 v22, v78, v78
v_lshlrev_b32 v78, 16, v22
v_lshlrev_b32 v67, 16, v67
v_lshlrev_b32 v79, 16, v79
v_add_f32 v79, 1.0, v79
v_cvt_pk_bf16_f32 v22, v79, v79
v_lshlrev_b32 v79, 16, v22
v_lshlrev_b32 v68, 16, v68
v_lshlrev_b32 v80, 16, v80
v_add_f32 v80, 1.0, v80
v_cvt_pk_bf16_f32 v22, v80, v80
v_lshlrev_b32 v80, 16, v22
v_lshlrev_b32 v69, 16, v69
v_lshlrev_b32 v81, 16, v81
v_add_f32 v81, 1.0, v81
v_cvt_pk_bf16_f32 v22, v81, v81
v_lshlrev_b32 v81, 16, v22
v_lshlrev_b32 v70, 16, v70
v_lshlrev_b32 v82, 16, v82
v_add_f32 v82, 1.0, v82
v_cvt_pk_bf16_f32 v22, v82, v82
v_lshlrev_b32 v82, 16, v22
v_lshlrev_b32 v71, 16, v71
v_lshlrev_b32 v83, 16, v83
v_add_f32 v83, 1.0, v83
v_cvt_pk_bf16_f32 v22, v83, v83
v_lshlrev_b32 v83, 16, v22
v_lshlrev_b32 v72, 16, v72
v_lshlrev_b32 v84, 16, v84
v_add_f32 v84, 1.0, v84
v_cvt_pk_bf16_f32 v22, v84, v84
v_lshlrev_b32 v84, 16, v22
s_mul_i32 s66, s34, 3072
s_add_u32 s66, s66, 786432
s_cmp_ge_i32 s83, 54
s_cbranch_scc1 D_88
W_87:
ds_read_b32 v5, v3 offset:0
s_waitcnt lgkmcnt(0)
v_readfirstlane_b32 s83, v5
s_cmp_ge_i32 s83, 54
s_cbranch_scc1 D_88
s_sub_u32 s41, s41, 1
s_cbranch_scc1 L_bail
s_sleep 1
s_branch W_87
D_88:
ds_read_b64_tr_b16 v[128:129], v14 offset:8192
ds_read_b64_tr_b16 v[130:131], v14 offset:8704
ds_read_b64_tr_b16 v[132:133], v14 offset:16384
ds_read_b64_tr_b16 v[134:135], v14 offset:16896
ds_read_b64_tr_b16 v[136:137], v14 offset:24576
ds_read_b64_tr_b16 v[138:139], v14 offset:25088
ds_read_b64_tr_b16 v[140:141], v14 offset:32768
ds_read_b64_tr_b16 v[142:143], v14 offset:33280
ds_read_b64_tr_b16 v[144:145], v14 offset:40960
ds_read_b64_tr_b16 v[146:147], v14 offset:41472
ds_read_b64_tr_b16 v[148:149], v14 offset:49152
ds_read_b64_tr_b16 v[150:151], v14 offset:49664
ds_read_b64_tr_b16 v[152:153], v14 offset:57344
ds_read_b64_tr_b16 v[154:155], v14 offset:57856
ds_read_b64_tr_b16 v[156:157], v15 offset:0
ds_read_b64_tr_b16 v[158:159], v15 offset:512
ds_read_b64_tr_b16 v[160:161], v15 offset:8192
ds_read_b64_tr_b16 v[162:163], v15 offset:8704
s_cmp_ge_i32 s83, 60
s_cbranch_scc1 D_90
W_89:
ds_read_b32 v5, v3 offset:0
s_waitcnt lgkmcnt(0)
v_readfirstlane_b32 s83, v5
s_cmp_ge_i32 s83, 60
s_cbranch_scc1 D_90
s_sub_u32 s41, s41, 1
s_cbranch_scc1 L_bail
s_sleep 1
s_branch W_89
D_90:
s_mul_i32 s65, s32, 12288
s_add_u32 s65, s65, 4294836224
s_mov_b32 s68, 0
G_91:
s_add_u32 s68, s68, 1
s_and_b32 s67, s68, 63
s_cselect_b32 s67, s65, 0
s_add_u32 s67, s67, s66
buffer_load_dwordx4 v[28:31], v16, s[36:39], s67 offen offset:0 sc1
buffer_load_dwordx4 v[32:35], v16, s[36:39], s67 offen offset:1024 sc1
buffer_load_dwordx4 v[36:39], v16, s[36:39], s67 offen offset:2048 sc1
s_sub_u32 s41, s41, 16
s_cbranch_scc1 L_bail
s_waitcnt vmcnt(2)
v_xor_b32 v22, s40, v31
s_waitcnt vmcnt(1)
v_bitop3_b32 v22, v22, v35, s40 bitop3:0xf6
s_waitcnt vmcnt(0)
v_bitop3_b32 v22, v22, v39, s40 bitop3:0xf6
v_cmp_ne_u32 vcc, 0, v22
s_cbranch_vccnz G_91
v_readfirstlane_b32 s50, v28
s_nop 1
v_subrev_f32 v28, s50, v28
v_subrev_f32 v29, s50, v29
v_subrev_f32 v30, s50, v30
v_subrev_f32 v32, s50, v32
v_subrev_f32 v33, s50, v33
v_subrev_f32 v34, s50, v34
v_subrev_f32 v36, s50, v36
v_subrev_f32 v37, s50, v37
v_subrev_f32 v38, s50, v38
v_add_f32 v20, v28, v29
v_mul_f32 v21, v28, v28
v_fmac_f32 v21, v29, v29
v_add_f32 v20, v20, v30
v_fmac_f32 v21, v30, v30
v_add_f32 v20, v20, v32
v_fmac_f32 v21, v32, v32
v_add_f32 v20, v20, v33
v_fmac_f32 v21, v33, v33
v_add_f32 v20, v20, v34
v_fmac_f32 v21, v34, v34
v_add_f32 v20, v20, v36
v_fmac_f32 v21, v36, v36
v_add_f32 v20, v20, v37
v_fmac_f32 v21, v37, v37
v_add_f32 v20, v20, v38
v_fmac_f32 v21, v38, v38
s_nop 0
v_add_f32_dpp v20, v20, v20 quad_perm:[1,0,3,2] row_mask:0xf bank_mask:0xf
v_add_f32_dpp v21, v21, v21 quad_perm:[1,0,3,2] row_mask:0xf bank_mask:0xf
s_nop 0
v_add_f32_dpp v20, v20, v20 quad_perm:[2,3,0,1] row_mask:0xf bank_mask:0xf
v_add_f32_dpp v21, v21, v21 quad_perm:[2,3,0,1] row_mask:0xf bank_mask:0xf
s_nop 0
v_add_f32_dpp v20, v20, v20 row_half_mirror row_mask:0xf bank_mask:0xf
v_add_f32_dpp v21, v21, v21 row_half_mirror row_mask:0xf bank_mask:0xf
s_nop 0
v_add_f32_dpp v20, v20, v20 row_mirror row_mask:0xf bank_mask:0xf
v_add_f32_dpp v21, v21, v21 row_mirror row_mask:0xf bank_mask:0xf
v_mov_b32 v22, v20
v_mov_b32 v23, v21
s_nop 1
v_permlane16_swap_b32 v20, v22
v_permlane16_swap_b32 v21, v23
v_add_f32 v20, v20, v22
v_add_f32 v21, v21, v23
v_mov_b32 v22, v20
v_mov_b32 v23, v21
s_nop 1
v_permlane32_swap_b32 v20, v22
v_permlane32_swap_b32 v21, v23
v_add_f32 v20, v20, v22
v_add_f32 v21, v21, v23
v_mul_f32 v20, 0x3ae38e39, v20
v_mov_b32 v22, 0x3727c5ac
v_fmac_f32 v22, 0x3ae38e39, v21
v_fma_f32 v22, -v20, v20, v22
v_max_f32 v22, 0x3727c5ac, v22
v_rsq_f32 v22, v22
v_sub_f32 v28, v28, v20
v_sub_f32 v29, v29, v20
v_sub_f32 v30, v30, v20
v_sub_f32 v32, v32, v20
v_sub_f32 v33, v33, v20
v_sub_f32 v34, v34, v20
v_sub_f32 v36, v36, v20
v_sub_f32 v37, v37, v20
v_sub_f32 v38, v38, v20
v_mul_f32 v76, v76, v22
v_mul_f32 v77, v77, v22
v_mul_f32 v78, v78, v22
v_mul_f32 v79, v79, v22
v_mul_f32 v80, v80, v22
v_mul_f32 v81, v81, v22
v_mul_f32 v82, v82, v22
v_mul_f32 v83, v83, v22
v_mul_f32 v84, v84, v22
v_fma_f32 v28, v28, v76, v64
v_fma_f32 v29, v29, v77, v65
v_fma_f32 v30, v30, v78, v66
v_fma_f32 v32, v32, v79, v67
v_fma_f32 v33, v33, v80, v68
v_fma_f32 v34, v34, v81, v69
v_fma_f32 v36, v36, v82, v70
v_fma_f32 v37, v37, v83, v71
v_fma_f32 v38, v38, v84, v72
v_cvt_pk_bf16_f32 v28, v28, v29
v_cvt_pk_bf16_f32 v30, v30, v32
v_cvt_pk_bf16_f32 v33, v33, v34
v_cvt_pk_bf16_f32 v36, v36, v37
v_cvt_pk_bf16_f32 v38, v38, v38
ds_write_b16 v12, v28 offset:0
ds_write_b16_d16_hi v12, v28 offset:32
ds_write_b16 v12, v30 offset:64
ds_write_b16_d16_hi v12, v30 offset:384
ds_write_b16 v12, v33 offset:416
ds_write_b16_d16_hi v12, v33 offset:448
ds_write_b16 v12, v36 offset:768
ds_write_b16_d16_hi v12, v36 offset:800
ds_write_b16 v12, v38 offset:832
s_mov_b64 exec, 1
ds_add_u32 v3, v4 offset:40
s_mov_b64 exec, -1
W_gu:
W_92:
ds_read_b32 v5, v3 offset:40
s_waitcnt lgkmcnt(0)
v_cmp_le_i32 vcc, 4, v5
s_cbranch_vccnz D_93
s_sub_u32 s41, s41, 1
s_cbranch_scc1 L_bail
s_branch W_92
D_93:
ds_read_b128 v[28:31], v19 offset:0
ds_read_b128 v[32:35], v19 offset:64
ds_read_b128 v[36:39], v19 offset:128
ds_read_b128 v[40:43], v19 offset:192
ds_read_b128 v[44:47], v19 offset:256
ds_read_b128 v[48:51], v19 offset:320
ds_read_b128 v[52:55], v19 offset:384
ds_read_b128 v[56:59], v19 offset:448
ds_read_b128 v[60:63], v19 offset:512
s_waitcnt lgkmcnt(8)
v_mfma_f32_16x16x32_bf16 v[20:23], v[92:95], v[28:31], 0
ds_read_b128 v[28:31], v19 offset:576
s_waitcnt lgkmcnt(8)
v_mfma_f32_16x16x32_bf16 v[20:23], v[96:99], v[32:35], v[20:23]
ds_read_b128 v[32:35], v19 offset:640
s_waitcnt lgkmcnt(8)
v_mfma_f32_16x16x32_bf16 v[20:23], v[100:103], v[36:39], v[20:23]
ds_read_b128 v[36:39], v19 offset:704
s_waitcnt lgkmcnt(8)
v_mfma_f32_16x16x32_bf16 v[20:23], v[104:107], v[40:43], v[20:23]
ds_read_b128 v[40:43], v19 offset:768
s_waitcnt lgkmcnt(8)
v_mfma_f32_16x16x32_bf16 v[20:23], v[108:111], v[44:47], v[20:23]
ds_read_b128 v[44:47], v19 offset:832
s_waitcnt lgkmcnt(8)
v_mfma_f32_16x16x32_bf16 v[20:23], v[112:115], v[48:51], v[20:23]
ds_read_b128 v[48:51], v19 offset:896
s_waitcnt lgkmcnt(8)
v_mfma_f32_16x16x32_bf16 v[20:23], v[116:119], v[52:55], v[20:23]
ds_read_b128 v[52:55], v19 offset:960
s_waitcnt lgkmcnt(8)
v_mfma_f32_16x16x32_bf16 v[20:23], v[120:123], v[56:59], v[20:23]
ds_read_b128 v[56:59], v19 offset:1024
s_waitcnt lgkmcnt(8)
v_mfma_f32_16x16x32_bf16 v[20:23], v[124:127], v[60:63], v[20:23]
ds_read_b128 v[60:63], v19 offset:1088
s_waitcnt lgkmcnt(8)
v_mfma_f32_16x16x32_bf16 v[20:23], v[128:131], v[28:31], v[20:23]
s_waitcnt lgkmcnt(7)
v_mfma_f32_16x16x32_bf16 v[20:23], v[132:135], v[32:35], v[20:23]
s_waitcnt lgkmcnt(6)
v_mfma_f32_16x16x32_bf16 v[20:23], v[136:139], v[36:39], v[20:23]
s_waitcnt lgkmcnt(5)
v_mfma_f32_16x16x32_bf16 v[20:23], v[140:143], v[40:43], v[20:23]
s_waitcnt lgkmcnt(4)
v_mfma_f32_16x16x32_bf16 v[20:23], v[144:147], v[44:47], v[20:23]
s_waitcnt lgkmcnt(3)
v_mfma_f32_16x16x32_bf16 v[20:23], v[148:151], v[48:51], v[20:23]
s_waitcnt lgkmcnt(2)
v_mfma_f32_16x16x32_bf16 v[20:23], v[152:155], v[52:55], v[20:23]
s_waitcnt lgkmcnt(1)
v_mfma_f32_16x16x32_bf16 v[20:23], v[156:159], v[56:59], v[20:23]
s_waitcnt lgkmcnt(0)
v_mfma_f32_16x16x32_bf16 v[20:23], v[160:163], v[60:63], v[20:23]
s_cmp_ge_u32 s35, 4
s_cbranch_scc1 W_nd
s_cmp_ge_i32 s83, 72
s_cbranch_scc1 D_95
W_94:
ds_read_b32 v5, v3 offset:0
s_waitcnt lgkmcnt(0)
v_readfirstlane_b32 s83, v5
s_cmp_ge_i32 s83, 72
s_cbranch_scc1 D_95
s_sub_u32 s41, s41, 1
s_cbranch_scc1 L_bail
s_branch W_94
D_95:
ds_read_b64_tr_b16 v[92:93], v16 offset:0
ds_read_b64_tr_b16 v[94:95], v16 offset:512
ds_read_b64_tr_b16 v[96:97], v17 offset:0
ds_read_b64_tr_b16 v[98:99], v17 offset:512
ds_read_b64_tr_b16 v[100:101], v18 offset:0
ds_read_b64_tr_b16 v[102:103], v18 offset:512
ds_read_b64_tr_b16 v[128:129], v16 offset:36864
ds_read_b64_tr_b16 v[130:131], v16 offset:37376
ds_read_b64_tr_b16 v[132:133], v17 offset:36864
ds_read_b64_tr_b16 v[134:135], v17 offset:37376
ds_read_b64_tr_b16 v[136:137], v18 offset:36864
ds_read_b64_tr_b16 v[138:139], v18 offset:37376
W_nd:
s_nop 5
v_permlane32_swap_b32 v20, v22
v_permlane32_swap_b32 v21, v23
v_cvt_pk_bf16_f32 v24, v20, v21
v_lshlrev_b32 v20, 16, v24
v_and_b32 v21, 0xffff0000, v24
v_cvt_pk_bf16_f32 v24, v22, v23
v_lshlrev_b32 v22, 16, v24
v_and_b32 v23, 0xffff0000, v24
v_mul_f32 v24, v20, v20
v_mul_f32 v25, v21, v21
v_mov_b32 v26, 0xc0135761
v_fmamk_f32 v24, v24, 0xbdd2d3e8, v26
v_fmamk_f32 v25, v25, 0xbdd2d3e8, v26
v_mul_f32 v24, v24, v20
v_mul_f32 v25, v25, v21
v_exp_f32 v24, v24
v_exp_f32 v25, v25
s_nop 0
v_add_f32 v24, 1.0, v24
v_add_f32 v25, 1.0, v25
v_rcp_f32 v24, v24
v_rcp_f32 v25, v25
s_nop 0
v_mul_f32 v20, v20, v24
v_mul_f32 v21, v21, v25
v_cvt_pk_bf16_f32 v24, v20, v21
v_lshlrev_b32 v20, 16, v24
v_and_b32 v21, 0xffff0000, v24
v_mul_f32 v20, v20, v22
v_mul_f32 v21, v21, v23
v_cvt_pk_bf16_f32 v20, v20, v21
s_mov_b32 exec_lo, 0x000f000f
s_mov_b32 exec_hi, 0x000f000f
ds_write_b32 v11, v20
s_mov_b64 exec, 1
ds_add_u32 v3, v4 offset:44
s_mov_b64 exec, -1
s_cmp_ge_u32 s35, 4
s_cbranch_scc1 L_exit
ds_read_b64_tr_b16 v[104:105], v16 offset:12288
ds_read_b64_tr_b16 v[106:107], v16 offset:12800
ds_read_b64_tr_b16 v[108:109], v17 offset:12288
ds_read_b64_tr_b16 v[110:111], v17 offset:12800
ds_read_b64_tr_b16 v[112:113], v18 offset:12288
ds_read_b64_tr_b16 v[114:115], v18 offset:12800
ds_read_b64_tr_b16 v[140:141], v16 offset:49152
ds_read_b64_tr_b16 v[142:143], v16 offset:49664
ds_read_b64_tr_b16 v[144:145], v17 offset:49152
ds_read_b64_tr_b16 v[146:147], v17 offset:49664
ds_read_b64_tr_b16 v[148:149], v18 offset:49152
ds_read_b64_tr_b16 v[150:151], v18 offset:49664
ds_read_b64_tr_b16 v[116:117], v16 offset:24576
ds_read_b64_tr_b16 v[118:119], v16 offset:25088
ds_read_b64_tr_b16 v[120:121], v17 offset:24576
ds_read_b64_tr_b16 v[122:123], v17 offset:25088
ds_read_b64_tr_b16 v[124:125], v18 offset:24576
ds_read_b64_tr_b16 v[126:127], v18 offset:25088
ds_read_b64_tr_b16 v[152:153], v16 offset:61440
ds_read_b64_tr_b16 v[154:155], v16 offset:61952
ds_read_b64_tr_b16 v[156:157], v17 offset:61440
ds_read_b64_tr_b16 v[158:159], v17 offset:61952
ds_read_b64_tr_b16 v[160:161], v18 offset:61440
ds_read_b64_tr_b16 v[162:163], v18 offset:61952
W_96:
ds_read_b32 v5, v3 offset:44
s_waitcnt lgkmcnt(0)
v_cmp_le_i32 vcc, 8, v5
s_cbranch_vccnz D_97
s_sub_u32 s41, s41, 1
s_cbranch_scc1 L_bail
s_branch W_96
D_97:
ds_read_b128 v[20:23], v10
ds_read_b128 v[24:27], v10 offset:64
s_waitcnt lgkmcnt(0)
v_mfma_f32_16x16x32_bf16 v[28:31], v[92:95], v[20:23], 0
v_mfma_f32_16x16x32_bf16 v[32:35], v[96:99], v[20:23], 0
v_mfma_f32_16x16x32_bf16 v[36:39], v[100:103], v[20:23], 0
v_mfma_f32_16x16x32_bf16 v[28:31], v[128:131], v[24:27], v[28:31]
v_mfma_f32_16x16x32_bf16 v[32:35], v[132:135], v[24:27], v[32:35]
v_mfma_f32_16x16x32_bf16 v[36:39], v[136:139], v[24:27], v[36:39]
v_mfma_f32_16x16x32_bf16 v[40:43], v[104:107], v[20:23], 0
v_mfma_f32_16x16x32_bf16 v[44:47], v[108:111], v[20:23], 0
v_mfma_f32_16x16x32_bf16 v[48:51], v[112:115], v[20:23], 0
v_mfma_f32_16x16x32_bf16 v[40:43], v[140:143], v[24:27], v[40:43]
v_mfma_f32_16x16x32_bf16 v[44:47], v[144:147], v[24:27], v[44:47]
v_mfma_f32_16x16x32_bf16 v[48:51], v[148:151], v[24:27], v[48:51]
s_nop 1
v_cndmask_b32 v64, v28, v29, s[70:71]
v_cndmask_b32 v65, v32, v33, s[70:71]
v_cndmask_b32 v66, v36, v37, s[70:71]
v_cndmask_b32 v64, v64, v30, s[72:73]
v_cndmask_b32 v65, v65, v34, s[72:73]
v_cndmask_b32 v66, v66, v38, s[72:73]
v_cndmask_b32 v64, v64, v31, s[74:75]
v_cndmask_b32 v65, v65, v35, s[74:75]
v_cndmask_b32 v66, v66, v39, s[74:75]
buffer_store_dwordx4 v[64:67], v12, s[36:39], s66 offen sc1
v_mfma_f32_16x16x32_bf16 v[52:55], v[116:119], v[20:23], 0
v_mfma_f32_16x16x32_bf16 v[56:59], v[120:123], v[20:23], 0
v_mfma_f32_16x16x32_bf16 v[60:63], v[124:127], v[20:23], 0
v_mfma_f32_16x16x32_bf16 v[52:55], v[152:155], v[24:27], v[52:55]
v_mfma_f32_16x16x32_bf16 v[56:59], v[156:159], v[24:27], v[56:59]
v_mfma_f32_16x16x32_bf16 v[60:63], v[160:163], v[24:27], v[60:63]
v_cndmask_b32 v68, v40, v41, s[70:71]
v_cndmask_b32 v69, v44, v45, s[70:71]
v_cndmask_b32 v70, v48, v49, s[70:71]
v_cndmask_b32 v68, v68, v42, s[72:73]
v_cndmask_b32 v69, v69, v46, s[72:73]
v_cndmask_b32 v70, v70, v50, s[72:73]
v_cndmask_b32 v68, v68, v43, s[74:75]
v_cndmask_b32 v69, v69, v47, s[74:75]
v_cndmask_b32 v70, v70, v51, s[74:75]
buffer_store_dwordx4 v[68:71], v12, s[36:39], s67 offen sc1
v_cndmask_b32 v72, v52, v53, s[70:71]
v_cndmask_b32 v73, v56, v57, s[70:71]
v_cndmask_b32 v74, v60, v61, s[70:71]
v_cndmask_b32 v72, v72, v54, s[72:73]
v_cndmask_b32 v73, v73, v58, s[72:73]
v_cndmask_b32 v74, v74, v62, s[72:73]
v_cndmask_b32 v72, v72, v55, s[74:75]
v_cndmask_b32 v73, v73, v59, s[74:75]
v_cndmask_b32 v74, v74, v63, s[74:75]
buffer_store_dwordx4 v[72:75], v12, s[36:39], s68 offen sc1
s_cmp_lg_u32 s35, 0
s_cbranch_scc1 L_exit
s_lshl_b32 s50, s32, 12
s_lshl_b32 s51, s79, 7
s_add_u32 s50, s50, s51
s_add_u32 s50, s50, 917504
v_mov_b32 v20, s40
v_lshlrev_b32 v21, 2, v0
s_mov_b64 exec, 0xffffffff
buffer_store_dword v20, v21, s[36:39], s50 offen
s_mov_b64 exec, -1
s_branch L_exit
L_awave:
v_xor_b32 v6, v2, v1
s_lshl_b32 s50, s35, 14
v_lshl_add_u32 v7, v1, 8, s50
v_xor_b32 v8, 0, v6
v_lshl_add_u32 v10, v8, 4, v7
v_xor_b32 v8, 4, v6
v_lshl_add_u32 v11, v8, 4, v7
v_xor_b32 v8, 8, v6
v_lshl_add_u32 v12, v8, 4, v7
v_xor_b32 v8, 12, v6
v_lshl_add_u32 v13, v8, 4, v7
v_and_b32 v6, 1, v1
v_mul_u32_u24 v6, 320, v6
v_lshl_add_u32 v6, v2, 4, v6
v_add_u32 v14, 147968, v6
v_and_b32 v6, 1, v1
v_mul_u32_u24 v6, 1088, v6
v_lshl_add_u32 v6, v2, 4, v6
v_add_u32 v15, 148736, v6
v_lshrrev_b32 v6, 2, v1
v_and_b32 v7, 1, v2
v_lshl_or_b32 v7, v7, 2, v6
v_lshl_add_u32 v6, v2, 3, v6
v_lshlrev_b32 v6, 8, v6
v_and_b32 v8, 3, v1
v_lshl_add_u32 v6, v8, 3, v6
v_xor_b32 v7, s35, v7
v_lshl_add_u32 v16, v7, 5, v6
v_add_u32 v17, 0x10000, v16
v_add_u32 v9, 0x20000, v16
v_and_b32 v6, 1, v1
v_mul_u32_u24 v7, 1088, v6
v_lshl_add_u32 v7, v2, 3, v7
v_and_b32 v8, 6, v1
v_lshl_add_u32 v7, v8, 4, v7
v_lshrrev_b32 v8, 3, v1
v_lshl_add_u32 v7, v8, 2, v7
s_lshl_b32 s50, s35, 7
s_add_u32 s50, s50, 148736
v_add_u32 v18, s50, v7
v_lshl_add_u32 v19, v6, 5, v3
s_lshl_b32 s50, s35, 2
v_add_u32 v20, s50, v19
s_lshl_b32 s50, s81, 13
v_lshl_add_u32 v21, v6, 12, s50
v_lshl_add_u32 v21, v2, 4, v21
s_lshl_b32 s67, s80, 10
s_lshl_b32 s50, s82, 9
s_add_u32 s67, s67, s50
s_lshl_b32 s50, s35, 6
s_add_u32 s67, s67, s50
s_add_u32 s67, s67, 131072
s_add_u32 s76, s67, 2818048
s_and_b32 s50, s35, 4
v_add_u32 v22, s50, v3
s_lshl_b32 s68, s35, 2
s_add_u32 s68, s68, 4
s_cmp_ge_i32 s83, s68
s_cbranch_scc1 D_99
W_98:
ds_read_b32 v5, v3 offset:0
s_waitcnt lgkmcnt(0)
v_readfirstlane_b32 s83, v5
s_cmp_ge_i32 s83, s68
s_cbranch_scc1 D_99
s_sub_u32 s41, s41, 1
s_cbranch_scc1 L_bail
s_sleep 1
s_branch W_98
D_99:
ds_read_b128 v[64:67], v10 offset:0
ds_read_b128 v[68:71], v11 offset:0
ds_read_b128 v[72:75], v12 offset:0
ds_read_b128 v[76:79], v13 offset:0
ds_read_b128 v[80:83], v10 offset:4096
ds_read_b128 v[84:87], v11 offset:4096
ds_read_b128 v[88:91], v12 offset:4096
ds_read_b128 v[92:95], v13 offset:4096
ds_read_b128 v[96:99], v10 offset:8192
ds_read_b128 v[100:103], v11 offset:8192
ds_read_b128 v[104:107], v12 offset:8192
ds_read_b128 v[108:111], v13 offset:8192
ds_read_b128 v[112:115], v10 offset:12288
ds_read_b128 v[116:119], v11 offset:12288
ds_read_b128 v[120:123], v12 offset:12288
ds_read_b128 v[124:127], v13 offset:12288
s_mov_b64 exec, 1
ds_add_u32 v22, v4 offset:8
s_mov_b64 exec, -1
s_cmp_lg_u32 s35, 0
s_cbranch_scc1 A_noq
s_lshl_b32 s68, s81, 10
s_lshl_b32 s50, s80, 14
s_add_u32 s68, s68, s50
s_add_u32 s68, s68, 65536
v_lshlrev_b32 v22, 4, v0
v_lshrrev_b32 v6, 5, v0
v_mul_u32_u24 v6, 320, v6
v_and_b32 v7, 31, v0
v_lshl_add_u32 v6, v7, 3, v6
v_add_u32 v23, 147968, v6
s_cmp_ge_i32 s83, 20
s_cbranch_scc1 D_101
W_100:
ds_read_b32 v5, v3 offset:0
s_waitcnt lgkmcnt(0)
v_readfirstlane_b32 s83, v5
s_cmp_ge_i32 s83, 20
s_cbranch_scc1 D_101
s_sub_u32 s41, s41, 1
s_cbranch_scc1 L_bail
s_sleep 1
s_branch W_100
D_101:
s_add_u32 s69, s68, 2818048
s_mov_b32 s70, 0
buffer_load_dwordx4 v[128:131], v22, s[36:39], s69 offen sc1
s_sleep 12
buffer_load_dwordx4 v[132:135], v22, s[36:39], s69 offen sc1
A_qp:
s_sub_u32 s41, s41, 64
s_cbranch_scc1 L_bail
s_add_u32 s70, s70, 1
s_and_b32 s71, s70, 7
s_cselect_b32 s71, s69, s68
s_waitcnt vmcnt(1)
v_cmp_ne_u32 vcc, s40, v130
s_cbranch_vccz A_qd0
s_sleep 1
buffer_load_dwordx4 v[128:131], v22, s[36:39], s71 offen sc1
s_waitcnt vmcnt(1)
v_cmp_ne_u32 vcc, s40, v134
s_cbranch_vccz A_qd1
s_sleep 1
buffer_load_dwordx4 v[132:135], v22, s[36:39], s69 offen sc1
s_branch A_qp
A_qd0:
ds_write_b64 v23, v[128:129]
s_branch A_qe
A_qd1:
ds_write_b64 v23, v[132:133]
A_qe:
s_mov_b64 exec, 1
ds_add_u32 v3, v4 offset:16
s_mov_b64 exec, -1
A_noq:
W_102:
ds_read_b32 v5, v3 offset:16
s_waitcnt lgkmcnt(0)
v_cmp_le_i32 vcc, 1, v5
s_cbranch_vccnz D_103
s_sub_u32 s41, s41, 1
s_cbranch_scc1 L_bail
s_sleep 1
s_branch W_102
D_103:
ds_read_b128 v[24:27], v14 offset:0
ds_read_b128 v[28:31], v14 offset:64
ds_read_b128 v[32:35], v14 offset:128
ds_read_b128 v[36:39], v14 offset:192
s_waitcnt lgkmcnt(3)
v_mfma_f32_16x16x32_bf16 v[40:43], v[64:67], v[24:27], 0
v_mfma_f32_16x16x32_bf16 v[44:47], v[80:83], v[24:27], 0
v_mfma_f32_16x16x32_bf16 v[48:51], v[96:99], v[24:27], 0
v_mfma_f32_16x16x32_bf16 v[52:55], v[112:115], v[24:27], 0
s_waitcnt lgkmcnt(2)
v_mfma_f32_16x16x32_bf16 v[40:43], v[68:71], v[28:31], v[40:43]
v_mfma_f32_16x16x32_bf16 v[44:47], v[84:87], v[28:31], v[44:47]
v_mfma_f32_16x16x32_bf16 v[48:51], v[100:103], v[28:31], v[48:51]
v_mfma_f32_16x16x32_bf16 v[52:55], v[116:119], v[28:31], v[52:55]
s_waitcnt lgkmcnt(1)
v_mfma_f32_16x16x32_bf16 v[40:43], v[72:75], v[32:35], v[40:43]
v_mfma_f32_16x16x32_bf16 v[44:47], v[88:91], v[32:35], v[44:47]
v_mfma_f32_16x16x32_bf16 v[48:51], v[104:107], v[32:35], v[48:51]
v_mfma_f32_16x16x32_bf16 v[52:55], v[120:123], v[32:35], v[52:55]
s_waitcnt lgkmcnt(0)
v_mfma_f32_16x16x32_bf16 v[40:43], v[76:79], v[36:39], v[40:43]
v_mfma_f32_16x16x32_bf16 v[44:47], v[92:95], v[36:39], v[44:47]
v_mfma_f32_16x16x32_bf16 v[48:51], v[108:111], v[36:39], v[48:51]
v_mfma_f32_16x16x32_bf16 v[52:55], v[124:127], v[36:39], v[52:55]
s_mov_b32 s70, 0xcccccccc
s_mov_b32 s71, 0xcccccccc
s_mov_b32 s72, 0xf0f0f0f0
s_mov_b32 s73, 0xf0f0f0f0
s_mov_b32 s74, 0xff00ff00
s_mov_b32 s75, 0xff00ff00
v_cndmask_b32 v40, v40, v42, s[74:75]
v_cndmask_b32 v41, v41, v43, s[74:75]
v_cndmask_b32 v44, v44, v46, s[74:75]
v_cndmask_b32 v45, v45, v47, s[74:75]
v_cndmask_b32 v48, v48, v50, s[74:75]
v_cndmask_b32 v49, v49, v51, s[74:75]
v_cndmask_b32 v52, v52, v54, s[74:75]
v_cndmask_b32 v53, v53, v55, s[74:75]
v_cndmask_b32 v40, v40, v44, s[70:71]
v_cndmask_b32 v48, v48, v52, s[70:71]
v_cndmask_b32 v41, v41, v45, s[70:71]
v_cndmask_b32 v49, v49, v53, s[70:71]
v_cndmask_b32 v40, v40, v48, s[72:73]
v_cndmask_b32 v41, v41, v49, s[72:73]
v_cvt_pk_bf16_f32 v22, v40, v41
v_lshlrev_b32 v40, 16, v22
v_and_b32 v41, 0xffff0000, v22
v_mul_f32 v40, 0x3db504f3, v40
v_mul_f32 v41, 0x3db504f3, v41
v_cvt_pk_bf16_f32 v22, v40, v41
v_lshlrev_b32 v40, 16, v22
v_and_b32 v41, 0xffff0000, v22
v_max_f32 v22, v40, v41
s_nop 1
v_max_f32_dpp v22, v22, v22 row_ror:8 row_mask:0xf bank_mask:0xf
s_nop 1
v_max_f32_dpp v22, v22, v22 row_ror:4 row_mask:0xf bank_mask:0xf
s_nop 1
v_max_f32_dpp v22, v22, v22 row_ror:2 row_mask:0xf bank_mask:0xf
v_mov_b32 v23, v22
s_nop 1
v_permlane16_swap_b32 v22, v23
v_max_f32 v22, v22, v23
v_mov_b32 v23, v22
s_nop 1
v_permlane32_swap_b32 v22, v23
v_max_f32 v22, v22, v23
s_mov_b64 exec, 3
ds_write_b32 v20, v22 offset:256
s_mov_b64 exec, 1
ds_add_u32 v3, v4 offset:20
s_mov_b64 exec, -1
W_104:
ds_read_b32 v5, v3 offset:20
s_waitcnt lgkmcnt(0)
v_cmp_le_i32 vcc, 8, v5
s_cbranch_vccnz D_105
s_sub_u32 s41, s41, 1
s_cbranch_scc1 L_bail
s_branch W_104
D_105:
ds_read_b128 v[24:27], v19 offset:256
ds_read_b128 v[28:31], v19 offset:272
s_mov_b32 s50, 0x3fb8aa3b
s_waitcnt lgkmcnt(0)
v_max3_f32 v22, v24, v25, v26
v_max3_f32 v23, v27, v28, v29
v_max3_f32 v22, v22, v30, v31
v_max_f32 v22, v22, v23
v_mul_f32 v22, 0x3fb8aa3b, v22
v_fma_f32 v40, v40, s50, -v22
v_fma_f32 v41, v41, s50, -v22
v_exp_f32 v40, v40
v_exp_f32 v41, v41
s_nop 0
v_cvt_pk_bf16_f32 v24, v40, v41
v_add_f32 v23, v40, v41
ds_write_b32 v18, v24
s_nop 1
v_add_f32_dpp v23, v23, v23 row_ror:8 row_mask:0xf bank_mask:0xf
s_nop 1
v_add_f32_dpp v23, v23, v23 row_ror:4 row_mask:0xf bank_mask:0xf
s_nop 1
v_add_f32_dpp v23, v23, v23 row_ror:2 row_mask:0xf bank_mask:0xf
v_mov_b32 v32, v23
s_nop 1
v_permlane16_swap_b32 v23, v32
v_add_f32 v23, v23, v32
v_mov_b32 v32, v23
s_nop 1
v_permlane32_swap_b32 v23, v32
v_add_f32 v23, v23, v32
s_mov_b64 exec, 3
ds_write_b32 v20, v23 offset:320
s_mov_b64 exec, 1
ds_add_u32 v3, v4 offset:24
s_mov_b64 exec, -1
W_106:
ds_read_b32 v5, v3 offset:24
s_waitcnt lgkmcnt(0)
v_cmp_le_i32 vcc, 8, v5
s_cbranch_vccnz D_107
s_sub_u32 s41, s41, 1
s_cbranch_scc1 L_bail
s_branch W_106
D_107:
ds_read_b128 v[24:27], v19 offset:320
ds_read_b128 v[36:39], v19 offset:336
ds_read_b128 v[64:67], v15 offset:0
ds_read_b128 v[68:71], v15 offset:64
ds_read_b128 v[72:75], v15 offset:128
ds_read_b128 v[76:79], v15 offset:192
ds_read_b128 v[80:83], v15 offset:256
ds_read_b128 v[84:87], v15 offset:320
ds_read_b128 v[88:91], v15 offset:384
ds_read_b128 v[92:95], v15 offset:448
s_waitcnt lgkmcnt(8)
ds_read_b128 v[96:99], v15 offset:512
ds_read_b128 v[100:103], v15 offset:576
ds_read_b128 v[104:107], v15 offset:640
ds_read_b128 v[108:111], v15 offset:704
ds_read_b128 v[112:115], v15 offset:768
ds_read_b128 v[116:119], v15 offset:832
ds_read_b128 v[120:123], v15 offset:896
ds_read_b128 v[124:127], v15 offset:960
v_pk_add_f32 v[24:25], v[24:25], v[26:27]
v_pk_add_f32 v[36:37], v[36:37], v[38:39]
v_pk_add_f32 v[24:25], v[24:25], v[36:37]
v_add_f32 v23, v24, v25
v_log_f32 v31, v23
v_rcp_f32 v23, v23
v_mov_b32 v30, s40
v_add_f32 v31, v31, v22
s_waitcnt lgkmcnt(0)
s_cmp_ge_i32 s83, 34
s_cbranch_scc1 D_109
W_108:
ds_read_b32 v5, v3 offset:0
s_waitcnt lgkmcnt(0)
v_readfirstlane_b32 s83, v5
s_cmp_ge_i32 s83, 34
s_cbranch_scc1 D_109
s_sub_u32 s41, s41, 1
s_cbranch_scc1 L_bail
s_sleep 1
s_branch W_108
D_109:
ds_read_b64_tr_b16 v[40:41], v9 offset:0
ds_read_b64_tr_b16 v[42:43], v9 offset:1024
s_cmp_ge_i32 s83, 36
s_cbranch_scc1 D_111
W_110:
ds_read_b32 v5, v3 offset:0
s_waitcnt lgkmcnt(0)
v_readfirstlane_b32 s83, v5
s_cmp_ge_i32 s83, 36
s_cbranch_scc1 D_111
s_sub_u32 s41, s41, 1
s_cbranch_scc1 L_bail
s_sleep 1
s_branch W_110
D_111:
ds_read_b64_tr_b16 v[44:45], v9 offset:8192
ds_read_b64_tr_b16 v[46:47], v9 offset:9216
s_cmp_ge_i32 s83, 38
s_cbranch_scc1 D_113
W_112:
ds_read_b32 v5, v3 offset:0
s_waitcnt lgkmcnt(0)
v_readfirstlane_b32 s83, v5
s_cmp_ge_i32 s83, 38
s_cbranch_scc1 D_113
s_sub_u32 s41, s41, 1
s_cbranch_scc1 L_bail
s_sleep 1
s_branch W_112
D_113:
ds_read_b64_tr_b16 v[48:49], v16 offset:0
ds_read_b64_tr_b16 v[50:51], v16 offset:1024
s_waitcnt lgkmcnt(4)
v_mfma_f32_16x16x32_bf16 v[32:35], v[40:43], v[64:67], 0
s_cmp_ge_i32 s83, 40
s_cbranch_scc1 D_115
W_114:
ds_read_b32 v5, v3 offset:0
s_waitcnt lgkmcnt(0)
v_readfirstlane_b32 s83, v5
s_cmp_ge_i32 s83, 40
s_cbranch_scc1 D_115
s_sub_u32 s41, s41, 1
s_cbranch_scc1 L_bail
s_sleep 1
s_branch W_114
D_115:
ds_read_b64_tr_b16 v[52:53], v16 offset:8192
ds_read_b64_tr_b16 v[54:55], v16 offset:9216
s_waitcnt lgkmcnt(4)
v_mfma_f32_16x16x32_bf16 v[32:35], v[44:47], v[68:71], v[32:35]
s_cmp_ge_i32 s83, 42
s_cbranch_scc1 D_117
W_116:
ds_read_b32 v5, v3 offset:0
s_waitcnt lgkmcnt(0)
v_readfirstlane_b32 s83, v5
s_cmp_ge_i32 s83, 42
s_cbranch_scc1 D_117
s_sub_u32 s41, s41, 1
s_cbranch_scc1 L_bail
s_sleep 1
s_branch W_116
D_117:
ds_read_b64_tr_b16 v[40:41], v16 offset:16384
ds_read_b64_tr_b16 v[42:43], v16 offset:17408
s_waitcnt lgkmcnt(4)
v_mfma_f32_16x16x32_bf16 v[32:35], v[48:51], v[72:75], v[32:35]
s_cmp_ge_i32 s83, 44
s_cbranch_scc1 D_119
W_118:
ds_read_b32 v5, v3 offset:0
s_waitcnt lgkmcnt(0)
v_readfirstlane_b32 s83, v5
s_cmp_ge_i32 s83, 44
s_cbranch_scc1 D_119
s_sub_u32 s41, s41, 1
s_cbranch_scc1 L_bail
s_sleep 1
s_branch W_118
D_119:
ds_read_b64_tr_b16 v[44:45], v16 offset:24576
ds_read_b64_tr_b16 v[46:47], v16 offset:25600
s_waitcnt lgkmcnt(4)
v_mfma_f32_16x16x32_bf16 v[32:35], v[52:55], v[76:79], v[32:35]
s_cmp_ge_i32 s83, 46
s_cbranch_scc1 D_121
W_120:
ds_read_b32 v5, v3 offset:0
s_waitcnt lgkmcnt(0)
v_readfirstlane_b32 s83, v5
s_cmp_ge_i32 s83, 46
s_cbranch_scc1 D_121
s_sub_u32 s41, s41, 1
s_cbranch_scc1 L_bail
s_sleep 1
s_branch W_120
D_121:
ds_read_b64_tr_b16 v[48:49], v16 offset:32768
ds_read_b64_tr_b16 v[50:51], v16 offset:33792
s_waitcnt lgkmcnt(4)
v_mfma_f32_16x16x32_bf16 v[32:35], v[40:43], v[80:83], v[32:35]
s_cmp_ge_i32 s83, 48
s_cbranch_scc1 D_123
W_122:
ds_read_b32 v5, v3 offset:0
s_waitcnt lgkmcnt(0)
v_readfirstlane_b32 s83, v5
s_cmp_ge_i32 s83, 48
s_cbranch_scc1 D_123
s_sub_u32 s41, s41, 1
s_cbranch_scc1 L_bail
s_sleep 1
s_branch W_122
D_123:
ds_read_b64_tr_b16 v[52:53], v16 offset:40960
ds_read_b64_tr_b16 v[54:55], v16 offset:41984
s_waitcnt lgkmcnt(4)
v_mfma_f32_16x16x32_bf16 v[32:35], v[44:47], v[84:87], v[32:35]
s_cmp_ge_i32 s83, 50
s_cbranch_scc1 D_125
W_124:
ds_read_b32 v5, v3 offset:0
s_waitcnt lgkmcnt(0)
v_readfirstlane_b32 s83, v5
s_cmp_ge_i32 s83, 50
s_cbranch_scc1 D_125
s_sub_u32 s41, s41, 1
s_cbranch_scc1 L_bail
s_sleep 1
s_branch W_124
D_125:
ds_read_b64_tr_b16 v[40:41], v16 offset:49152
ds_read_b64_tr_b16 v[42:43], v16 offset:50176
s_waitcnt lgkmcnt(4)
v_mfma_f32_16x16x32_bf16 v[32:35], v[48:51], v[88:91], v[32:35]
s_cmp_ge_i32 s83, 52
s_cbranch_scc1 D_127
W_126:
ds_read_b32 v5, v3 offset:0
s_waitcnt lgkmcnt(0)
v_readfirstlane_b32 s83, v5
s_cmp_ge_i32 s83, 52
s_cbranch_scc1 D_127
s_sub_u32 s41, s41, 1
s_cbranch_scc1 L_bail
s_sleep 1
s_branch W_126
D_127:
ds_read_b64_tr_b16 v[44:45], v16 offset:57344
ds_read_b64_tr_b16 v[46:47], v16 offset:58368
s_waitcnt lgkmcnt(4)
v_mfma_f32_16x16x32_bf16 v[32:35], v[52:55], v[92:95], v[32:35]
s_cmp_ge_i32 s83, 54
s_cbranch_scc1 D_129
W_128:
ds_read_b32 v5, v3 offset:0
s_waitcnt lgkmcnt(0)
v_readfirstlane_b32 s83, v5
s_cmp_ge_i32 s83, 54
s_cbranch_scc1 D_129
s_sub_u32 s41, s41, 1
s_cbranch_scc1 L_bail
s_sleep 1
s_branch W_128
D_129:
ds_read_b64_tr_b16 v[48:49], v17 offset:0
ds_read_b64_tr_b16 v[50:51], v17 offset:1024
s_waitcnt lgkmcnt(4)
v_mfma_f32_16x16x32_bf16 v[32:35], v[40:43], v[96:99], v[32:35]
s_cmp_ge_i32 s83, 56
s_cbranch_scc1 D_131
W_130:
ds_read_b32 v5, v3 offset:0
s_waitcnt lgkmcnt(0)
v_readfirstlane_b32 s83, v5
s_cmp_ge_i32 s83, 56
s_cbranch_scc1 D_131
s_sub_u32 s41, s41, 1
s_cbranch_scc1 L_bail
s_sleep 1
s_branch W_130
D_131:
ds_read_b64_tr_b16 v[52:53], v17 offset:8192
ds_read_b64_tr_b16 v[54:55], v17 offset:9216
s_waitcnt lgkmcnt(4)
v_mfma_f32_16x16x32_bf16 v[32:35], v[44:47], v[100:103], v[32:35]
s_cmp_ge_i32 s83, 58
s_cbranch_scc1 D_133
W_132:
ds_read_b32 v5, v3 offset:0
s_waitcnt lgkmcnt(0)
v_readfirstlane_b32 s83, v5
s_cmp_ge_i32 s83, 58
s_cbranch_scc1 D_133
s_sub_u32 s41, s41, 1
s_cbranch_scc1 L_bail
s_sleep 1
s_branch W_132
D_133:
ds_read_b64_tr_b16 v[40:41], v17 offset:16384
ds_read_b64_tr_b16 v[42:43], v17 offset:17408
s_waitcnt lgkmcnt(4)
v_mfma_f32_16x16x32_bf16 v[32:35], v[48:51], v[104:107], v[32:35]
s_cmp_ge_i32 s83, 60
s_cbranch_scc1 D_135
W_134:
ds_read_b32 v5, v3 offset:0
s_waitcnt lgkmcnt(0)
v_readfirstlane_b32 s83, v5
s_cmp_ge_i32 s83, 60
s_cbranch_scc1 D_135
s_sub_u32 s41, s41, 1
s_cbranch_scc1 L_bail
s_sleep 1
s_branch W_134
D_135:
ds_read_b64_tr_b16 v[44:45], v17 offset:24576
ds_read_b64_tr_b16 v[46:47], v17 offset:25600
s_waitcnt lgkmcnt(4)
v_mfma_f32_16x16x32_bf16 v[32:35], v[52:55], v[108:111], v[32:35]
s_cmp_ge_i32 s83, 62
s_cbranch_scc1 D_137
W_136:
ds_read_b32 v5, v3 offset:0
s_waitcnt lgkmcnt(0)
v_readfirstlane_b32 s83, v5
s_cmp_ge_i32 s83, 62
s_cbranch_scc1 D_137
s_sub_u32 s41, s41, 1
s_cbranch_scc1 L_bail
s_branch W_136
D_137:
ds_read_b64_tr_b16 v[48:49], v17 offset:32768
ds_read_b64_tr_b16 v[50:51], v17 offset:33792
s_waitcnt lgkmcnt(4)
v_mfma_f32_16x16x32_bf16 v[32:35], v[40:43], v[112:115], v[32:35]
s_cmp_ge_i32 s83, 64
s_cbranch_scc1 D_139
W_138:
ds_read_b32 v5, v3 offset:0
s_waitcnt lgkmcnt(0)
v_readfirstlane_b32 s83, v5
s_cmp_ge_i32 s83, 64
s_cbranch_scc1 D_139
s_sub_u32 s41, s41, 1
s_cbranch_scc1 L_bail
s_branch W_138
D_139:
ds_read_b64_tr_b16 v[52:53], v17 offset:40960
ds_read_b64_tr_b16 v[54:55], v17 offset:41984
s_waitcnt lgkmcnt(4)
v_mfma_f32_16x16x32_bf16 v[32:35], v[44:47], v[116:119], v[32:35]
s_waitcnt lgkmcnt(2)
v_mfma_f32_16x16x32_bf16 v[32:35], v[48:51], v[120:123], v[32:35]
s_waitcnt lgkmcnt(0)
v_mfma_f32_16x16x32_bf16 v[32:35], v[52:55], v[124:127], v[32:35]
s_mov_b32 exec_lo, 0x00030003
s_mov_b32 exec_hi, 0x00030003
s_nop 5
v_mul_f32 v32, v32, v23
v_mul_f32 v33, v33, v23
v_mul_f32 v34, v34, v23
v_mul_f32 v35, v35, v23
v_cvt_pk_bf16_f32 v28, v32, v33
v_cvt_pk_bf16_f32 v29, v34, v35
buffer_store_dwordx4 v[28:31], v21, s[36:39], s76 offen
buffer_store_dwordx4 v[28:31], v21, s[36:39], s67 offen sc1
s_mov_b64 exec, -1
s_cmp_lg_u32 s35, 7
s_cbranch_scc1 A_noas
s_sub_u32 s50, s33, 16
s_mul_i32 s60, s50, 5
s_mov_b32 s61, 5
s_cmp_lt_u32 s50, 12
s_cbranch_scc1 A_as0
s_sub_u32 s50, s50, 12
s_mul_i32 s60, s50, 5
s_add_u32 s60, s60, 60
s_mov_b32 s61, 5
A_as0:
s_lshl_b32 s60, s60, 13
s_mul_i32 s50, s32, 663552
s_add_u32 s60, s60, s50
v_lshl_add_u32 v6, v0, 7, s60
s_cmp_eq_u32 s61, 0
s_cbranch_scc1 L_exit
s_sleep 2
A_as:
v_min_u32 v7, 5308412, v6
global_load_dword v40, v7, s[20:21]
v_add_u32 v6, 8192, v6
s_sub_u32 s61, s61, 1
s_cmp_lg_u32 s61, 0
s_cbranch_scc1 A_as
s_branch L_exit
A_noas:
s_cmp_ge_u32 s35, 6
s_cbranch_scc1 L_exit
s_sub_u32 s61, s33, 16
s_mul_i32 s60, s61, 6
s_add_u32 s60, s60, s35
s_lshr_b32 s61, s61, 2
s_mul_i32 s50, s61, 24
s_sub_u32 s62, s60, s50
s_lshr_b32 s50, s62, 1
s_mul_i32 s50, s50, 48
s_and_b32 s51, s62, 1
s_lshl_b32 s51, s51, 3
s_add_u32 s62, s50, s51
v_and_b32 v6, 7, v0
v_add_u32 v6, s62, v6
s_mul_i32 s50, s61, 1152
v_lshl_add_u32 v10, v6, 1, s50
v_lshrrev_b32 v7, 2, v6
s_mul_i32 s50, s61, 13824
v_lshl_add_u32 v11, v7, 4, s50
s_mov_b32 s64, s60
v_lshlrev_b32 v12, 4, v0
s_mov_b32 s62, 8704
s_mov_b32 s63, 15616
global_load_ushort v20, v10, s[4:5] offset:0
global_load_ushort v21, v10, s[4:5] offset:32
global_load_ushort v22, v10, s[4:5] offset:64
G_140:
buffer_load_dwordx4 v[44:47], v11, s[36:39], s62 offen offset:0 sc1
buffer_load_dwordx4 v[48:51], v11, s[36:39], s62 offen offset:64 sc1
buffer_load_dwordx4 v[52:55], v11, s[36:39], s62 offen offset:128 sc1
s_sub_u32 s41, s41, 16
s_cbranch_scc1 L_bail
s_waitcnt vmcnt(2)
v_xor_b32 v23, s40, v46
s_waitcnt vmcnt(1)
v_bitop3_b32 v23, v23, v50, s40 bitop3:0xf6
s_waitcnt vmcnt(0)
v_bitop3_b32 v23, v23, v54, s40 bitop3:0xf6
v_cmp_ne_u32 vcc, 0, v23
s_cbranch_vccz D_141
s_sleep 2
s_branch G_140
D_141:
s_mov_b32 s70, 0xcccccccc
s_mov_b32 s71, 0xcccccccc
s_mov_b32 s72, 0xaaaaaaaa
s_mov_b32 s73, 0xaaaaaaaa
v_cndmask_b32 v44, v44, v45, s[70:71]
v_lshlrev_b32 v45, 16, v44
v_and_b32 v46, 0xffff0000, v44
v_cndmask_b32 v24, v45, v46, s[72:73]
v_cndmask_b32 v48, v48, v49, s[70:71]
v_lshlrev_b32 v49, 16, v48
v_and_b32 v50, 0xffff0000, v48
v_cndmask_b32 v25, v49, v50, s[72:73]
v_cndmask_b32 v52, v52, v53, s[70:71]
v_lshlrev_b32 v53, 16, v52
v_and_b32 v54, 0xffff0000, v52
v_cndmask_b32 v26, v53, v54, s[72:73]
v_lshlrev_b32 v20, 16, v20
v_lshlrev_b32 v21, 16, v21
v_lshlrev_b32 v22, 16, v22
s_lshl_b32 s74, s64, 11
s_add_u32 s74, s74, 393216
s_lshl_b32 s75, s64, 7
s_mul_i32 s76, s32, 12288
s_add_u32 s76, s76, s75
s_add_u32 s76, s76, 655360
s_add_u32 s75, s75, 786432
v_mov_b32 v19, s40
s_lshl_b32 s50, s32, 12
s_add_u32 s50, s50, 819200
s_mov_b32 s51, 60
v_min_u32 v44, 5, v0
v_lshlrev_b32 v44, 7, v44
H_142:
buffer_load_dword v45, v44, s[36:39], s50 offen sc1
s_sub_u32 s51, s51, 1
s_cbranch_scc1 D_143
s_waitcnt vmcnt(0)
v_cmp_ne_u32 vcc, s40, v45
s_cbranch_vccnz H_142
D_143:
G_144:
buffer_load_dwordx4 v[28:31], v12, s[36:39], s74 offen offset:0 sc1
buffer_load_dwordx4 v[32:35], v12, s[36:39], s74 offen offset:1024 sc1
s_sub_u32 s41, s41, 16
s_cbranch_scc1 L_bail
s_waitcnt vmcnt(1)
v_xor_b32 v23, s40, v31
s_waitcnt vmcnt(0)
v_bitop3_b32 v23, v23, v35, s40 bitop3:0xf6
v_cmp_ne_u32 vcc, 0, v23
s_cbranch_vccnz G_144
v_add_f32 v16, v28, v32
v_add_f32 v17, v29, v33
v_add_f32 v18, v30, v34
v_add_f32_dpp v16, v16, v16 row_ror:8 row_mask:0xf bank_mask:0xf
v_add_f32_dpp v17, v17, v17 row_ror:8 row_mask:0xf bank_mask:0xf
v_add_f32_dpp v18, v18, v18 row_ror:8 row_mask:0xf bank_mask:0xf
v_mov_b32 v28, v16
v_mov_b32 v29, v17
v_mov_b32 v30, v18
s_nop 1
v_permlane16_swap_b32 v16, v28
v_permlane16_swap_b32 v17, v29
v_permlane16_swap_b32 v18, v30
v_add_f32 v16, v16, v28
v_add_f32 v17, v17, v29
v_add_f32 v18, v18, v30
v_mov_b32 v28, v16
v_mov_b32 v29, v17
v_mov_b32 v30, v18
s_nop 1
v_permlane32_swap_b32 v16, v28
v_permlane32_swap_b32 v17, v29
v_permlane32_swap_b32 v18, v30
v_add_f32 v16, v16, v28
v_add_f32 v17, v17, v29
v_add_f32 v18, v18, v30
s_mov_b64 exec, 0xff
v_cvt_pk_bf16_f32 v28, v16, v17
v_lshlrev_b32 v16, 16, v28
v_and_b32 v17, 0xffff0000, v28
v_cvt_pk_bf16_f32 v29, v18, v18
v_lshlrev_b32 v18, 16, v29
v_mul_f32 v16, v16, v24
v_mul_f32 v17, v17, v25
v_mul_f32 v18, v18, v26
v_cvt_pk_bf16_f32 v28, v16, v17
v_lshlrev_b32 v16, 16, v28
v_and_b32 v17, 0xffff0000, v28
v_cvt_pk_bf16_f32 v29, v18, v18
v_lshlrev_b32 v18, 16, v29
v_add_f32 v16, v16, v20
v_add_f32 v17, v17, v21
v_add_f32 v18, v18, v22
v_cvt_pk_bf16_f32 v28, v16, v17
v_lshlrev_b32 v16, 16, v28
v_and_b32 v17, 0xffff0000, v28
v_cvt_pk_bf16_f32 v29, v18, v18
v_lshlrev_b32 v18, 16, v29
buffer_store_dwordx4 v[16:19], v12, s[36:39], s76 offen
s_cmp_lg_u32 s32, s35
s_cbranch_scc1 L_exit
buffer_store_dwordx4 v[16:19], v12, s[36:39], s75 offen sc1
s_mov_b64 exec, -1
G_145:
buffer_load_dwordx4 v[44:47], v11, s[36:39], s63 offen offset:0 sc1
buffer_load_dwordx4 v[48:51], v11, s[36:39], s63 offen offset:64 sc1
buffer_load_dwordx4 v[52:55], v11, s[36:39], s63 offen offset:128 sc1
s_sub_u32 s41, s41, 16
s_cbranch_scc1 L_bail
s_waitcnt vmcnt(2)
v_xor_b32 v23, s40, v46
s_waitcnt vmcnt(1)
v_bitop3_b32 v23, v23, v50, s40 bitop3:0xf6
s_waitcnt vmcnt(0)
v_bitop3_b32 v23, v23, v54, s40 bitop3:0xf6
v_cmp_ne_u32 vcc, 0, v23
s_cbranch_vccz D_146
s_sleep 2
s_branch G_145
D_146:
s_mov_b32 s70, 0xcccccccc
s_mov_b32 s71, 0xcccccccc
s_mov_b32 s72, 0xaaaaaaaa
s_mov_b32 s73, 0xaaaaaaaa
v_cndmask_b32 v44, v44, v45, s[70:71]
v_lshlrev_b32 v45, 16, v44
v_and_b32 v46, 0xffff0000, v44
v_cndmask_b32 v24, v45, v46, s[72:73]
v_cndmask_b32 v48, v48, v49, s[70:71]
v_lshlrev_b32 v49, 16, v48
v_and_b32 v50, 0xffff0000, v48
v_cndmask_b32 v25, v49, v50, s[72:73]
v_cndmask_b32 v52, v52, v53, s[70:71]
v_lshlrev_b32 v53, 16, v52
v_and_b32 v54, 0xffff0000, v52
v_cndmask_b32 v26, v53, v54, s[72:73]
s_mul_i32 s74, s64, 9216
s_add_u32 s74, s74, 1048576
s_add_u32 s76, s74, 4096
s_add_u32 s77, s74, 8192
s_lshl_b32 s50, s32, 12
s_add_u32 s50, s50, 917504
s_mov_b32 s51, 60
v_min_u32 v28, 8, v0
v_lshlrev_b32 v28, 7, v28
H_147:
buffer_load_dword v29, v28, s[36:39], s50 offen sc1
s_sub_u32 s51, s51, 1
s_cbranch_scc1 D_148
s_waitcnt vmcnt(0)
v_cmp_ne_u32 vcc, s40, v29
s_cbranch_vccnz H_147
D_148:
A_g6:
buffer_load_dwordx4 v[32:35], v12, s[36:39], s74 offen offset:0 sc1
buffer_load_dwordx4 v[36:39], v12, s[36:39], s74 offen offset:1024 sc1
buffer_load_dwordx4 v[40:43], v12, s[36:39], s74 offen offset:2048 sc1
buffer_load_dwordx4 v[44:47], v12, s[36:39], s74 offen offset:3072 sc1
buffer_load_dwordx4 v[48:51], v12, s[36:39], s76 offen offset:0 sc1
buffer_load_dwordx4 v[52:55], v12, s[36:39], s76 offen offset:1024 sc1
buffer_load_dwordx4 v[56:59], v12, s[36:39], s76 offen offset:2048 sc1
buffer_load_dwordx4 v[60:63], v12, s[36:39], s76 offen offset:3072 sc1
buffer_load_dwordx4 v[64:67], v12, s[36:39], s77 offen offset:0 sc1
s_sub_u32 s41, s41, 16
s_cbranch_scc1 L_bail
s_waitcnt vmcnt(8)
v_xor_b32 v23, s40, v35
s_waitcnt vmcnt(7)
v_bitop3_b32 v23, v23, v39, s40 bitop3:0xf6
v_add_f32 v20, v32, v36
v_add_f32 v21, v33, v37
v_add_f32 v22, v34, v38
s_waitcnt vmcnt(6)
v_bitop3_b32 v23, v23, v43, s40 bitop3:0xf6
v_add_f32 v20, v20, v40
v_add_f32 v21, v21, v41
v_add_f32 v22, v22, v42
s_waitcnt vmcnt(5)
v_bitop3_b32 v23, v23, v47, s40 bitop3:0xf6
v_add_f32 v20, v20, v44
v_add_f32 v21, v21, v45
v_add_f32 v22, v22, v46
s_waitcnt vmcnt(4)
v_bitop3_b32 v23, v23, v51, s40 bitop3:0xf6
v_add_f32 v20, v20, v48
v_add_f32 v21, v21, v49
v_add_f32 v22, v22, v50
s_waitcnt vmcnt(3)
v_bitop3_b32 v23, v23, v55, s40 bitop3:0xf6
v_add_f32 v20, v20, v52
v_add_f32 v21, v21, v53
v_add_f32 v22, v22, v54
s_waitcnt vmcnt(2)
v_bitop3_b32 v23, v23, v59, s40 bitop3:0xf6
v_add_f32 v20, v20, v56
v_add_f32 v21, v21, v57
v_add_f32 v22, v22, v58
s_waitcnt vmcnt(1)
v_bitop3_b32 v23, v23, v63, s40 bitop3:0xf6
v_add_f32 v20, v20, v60
v_add_f32 v21, v21, v61
v_add_f32 v22, v22, v62
s_waitcnt vmcnt(0)
v_bitop3_b32 v23, v23, v67, s40 bitop3:0xf6
v_cmp_ne_u32 vcc, 0, v23
v_add_f32 v20, v20, v64
v_add_f32 v21, v21, v65
v_add_f32 v22, v22, v66
s_cbranch_vccnz A_g6
v_add_f32_dpp v20, v20, v20 row_ror:8 row_mask:0xf bank_mask:0xf
v_add_f32_dpp v21, v21, v21 row_ror:8 row_mask:0xf bank_mask:0xf
v_add_f32_dpp v22, v22, v22 row_ror:8 row_mask:0xf bank_mask:0xf
v_mov_b32 v28, v20
v_mov_b32 v29, v21
v_mov_b32 v30, v22
s_nop 1
v_permlane16_swap_b32 v20, v28
v_permlane16_swap_b32 v21, v29
v_permlane16_swap_b32 v22, v30
v_add_f32 v20, v20, v28
v_add_f32 v21, v21, v29
v_add_f32 v22, v22, v30
v_mov_b32 v28, v20
v_mov_b32 v29, v21
v_mov_b32 v30, v22
s_nop 1
v_permlane32_swap_b32 v20, v28
v_permlane32_swap_b32 v21, v29
v_permlane32_swap_b32 v22, v30
v_add_f32 v20, v20, v28
v_add_f32 v21, v21, v29
v_add_f32 v22, v22, v30
s_mov_b64 exec, 0xff
v_cvt_pk_bf16_f32 v28, v20, v21
v_lshlrev_b32 v20, 16, v28
v_and_b32 v21, 0xffff0000, v28
v_cvt_pk_bf16_f32 v29, v22, v22
v_lshlrev_b32 v22, 16, v29
v_mul_f32 v20, v20, v24
v_mul_f32 v21, v21, v25
v_mul_f32 v22, v22, v26
v_cvt_pk_bf16_f32 v28, v20, v21
v_lshlrev_b32 v20, 16, v28
v_and_b32 v21, 0xffff0000, v28
v_cvt_pk_bf16_f32 v29, v22, v22
v_lshlrev_b32 v22, 16, v29
v_add_f32 v20, v20, v16
v_add_f32 v21, v21, v17
v_add_f32 v22, v22, v18
v_cvt_pk_bf16_f32 v20, v20, v21
v_cvt_pk_bf16_f32 v22, v22, v22
global_store_short v10, v20, s[26:27]
global_store_short_d16_hi v10, v20, s[26:27] offset:32
global_store_short v10, v22, s[26:27] offset:64
s_cmp_lg_u32 s64, 0
s_cbranch_scc1 A_noep
s_mov_b64 exec, 1
v_mov_b32 v12, 0
buffer_store_dword v19, v12, s[36:39], 0 offen sc1
A_noep:
s_mov_b64 exec, -1
s_branch L_exit
L_bail:
L_exit:
L_end:
s_endpgm
.section .rodata,"a"
.p2align 6
.amdhsa_kernel adaLN_cond__sliding_block_cached__glu_gated_geglu__decode_kernel
  .amdhsa_next_free_vgpr 168
  .amdhsa_next_free_sgpr 96
  .amdhsa_accum_offset 168
  .amdhsa_group_segment_fixed_size 0
  .amdhsa_kernarg_size 112
  .amdhsa_user_sgpr_count 2
  .amdhsa_user_sgpr_kernarg_segment_ptr 1
  .amdhsa_system_sgpr_workgroup_id_x 1
  .amdhsa_float_denorm_mode_32 3
.end_amdhsa_kernel
```
